```python
import torch

def _softmax(x, axis=-1):
    return torch.softmax(x, dim=axis)
def _gelu(x):
    return torch.nn.functional.gelu(x, approximate="tanh")
def _silu(x):
    return torch.nn.functional.silu(x)
def _sigmoid(x):
    return torch.sigmoid(x)
def _layernorm(x, axis=-1, eps=1e-5):
    m = x.mean(dim=axis, keepdim=True)
    v = x.var(dim=axis, keepdim=True, unbiased=False)
    return (x - m) / torch.sqrt(v + eps)
def _scatter_add(tgt, idx, src, axis=0):
    return tgt.clone().index_add_(axis, idx, src)
def _segment_sum(src, seg, n):
    out = torch.zeros((n,) + src.shape[1:], dtype=src.dtype)
    return out.index_add_(0, seg, src)
def _pad(x, pw):
    flat = tuple(v for pair in reversed(pw) for v in pair)
    return torch.nn.functional.pad(x, flat)

kernel_name = 'parallel_sum__sliding_block_cached__glu_gated_geglu__decode'

def setup_inputs():

    _w = (lambda a: (lambda t: t.to(torch.bfloat16) if t.is_floating_point() else t)(torch.as_tensor(a)))
    def _A_setup():
        B, Sq, D = 1, 1, 1024
        Hq, Hkv, Sk, Dh = 32, 4, 32768, 128
        assert Hq % Hkv == 0, (Hq, Hkv)
        return {
            "x": _w((lambda *s: torch.randn(*s, dtype=torch.bfloat16) * 0.05)(B, Sq, D)),
            "k_cache": _w((lambda *s: torch.randn(*s, dtype=torch.bfloat16) * 1.6)(B, Hkv, Sk, Dh)),
            "v_cache": _w((lambda *s: torch.randn(*s, dtype=torch.bfloat16) * 0.8)(B, Hkv, Sk, Dh)),
            "wq": _w((lambda *s: torch.randn(*s, dtype=torch.bfloat16) * 1.6)(D, Hq * Dh) * (D ** -0.5)),
            "wo": _w((lambda *s: torch.randn(*s, dtype=torch.bfloat16) * 0.8)(Hq * Dh, D) * ((Hq * Dh) ** -0.5)),
        }
    _A_in = _A_setup()

    def _B_setup():
        B, S, Dm, Df = 1, 1, 1024, 3584
        return {
            "x": _w((lambda *s: torch.randn(*s, dtype=torch.bfloat16) * 0.05)(B, S, Dm)),
            "w_gate": _w((lambda *s: torch.randn(*s, dtype=torch.bfloat16) * 0.8)(Dm, Df) * (Dm ** -0.5)),
            "w_up": _w((lambda *s: torch.randn(*s, dtype=torch.bfloat16) * 0.8)(Dm, Df) * (Dm ** -0.5)),
            "w_down": _w((lambda *s: torch.randn(*s, dtype=torch.bfloat16) * 0.8)(Df, Dm) * (Df ** -0.5)),
        }
    _B_in = _B_setup()

    return {
        "A_x": _A_in["x"],
        "A_k_cache": _A_in["k_cache"],
        "A_v_cache": _A_in["v_cache"],
        "A_wq": _A_in["wq"],
        "A_wo": _A_in["wo"],
        "B_x": _B_in["x"],
        "B_w_gate": _B_in["w_gate"],
        "B_w_up": _B_in["w_up"],
        "B_w_down": _B_in["w_down"],
    }

def reference(A_x, A_k_cache, A_v_cache, A_wq, A_wo, B_x, B_w_gate, B_w_up, B_w_down):
    def _A_ref(x, k_cache, v_cache, wq, wo):
        B, Sq, D = x.shape
        Hq, Dh = 32, 128
        Hkv, Sk = k_cache.shape[1], k_cache.shape[2]
        W = min(4096, max(256, Sk // 4))
        rep = Hq // Hkv
        q = (lambda x, *d: x.permute(*d))((x @ wq).reshape(B, Sq, Hq, Dh), 0, 2, 1, 3)
        k = (lambda x, n, axis: torch.repeat_interleave(x, n, dim=axis))(k_cache[:, :, Sk - W:, :], rep, axis=1)
        v = (lambda x, n, axis: torch.repeat_interleave(x, n, dim=axis))(v_cache[:, :, Sk - W:, :], rep, axis=1)
        scores = torch.einsum("bhqd,bhkd->bhqk", q, k) * (Dh ** -0.5)
        p = _softmax(scores, axis=-1)
        o = torch.einsum("bhqk,bhkd->bhqd", p, v)
        return (lambda x, *d: x.permute(*d))(o, 0, 2, 1, 3).reshape(B, Sq, Hq * Dh) @ wo

    def _B_ref(x, w_gate, w_up, w_down):
        g = torch.einsum("bsd,df->bsf", x, w_gate)
        u = torch.einsum("bsd,df->bsf", x, w_up)
        h = _gelu(g) * u
        return torch.einsum("bsf,fd->bsd", h, w_down)

    x = A_x
    xn = _layernorm(x, axis=-1)
    return x + _A_ref(xn, A_k_cache, A_v_cache, A_wq, A_wo) + _B_ref(xn, B_w_gate, B_w_up, B_w_down)
```

```asm
; @launch grid=(256,1,1) block=(512,1,1) lds=147456
.amdgcn_target "amdgcn-amd-amdhsa--gfx950"
.text
.globl parallel_sum__sliding_block_cached__glu_gated_geglu__decode_kernel
.p2align 8
.type parallel_sum__sliding_block_cached__glu_gated_geglu__decode_kernel,@function
parallel_sum__sliding_block_cached__glu_gated_geglu__decode_kernel:
  s_cmp_ge_u32 s2, 256
  s_cbranch_scc1 L_end
  s_load_dwordx2 s[52:53], s[0:1], 8
  s_load_dwordx2 s[32:33], s[0:1], 24
  s_load_dwordx2 s[28:29], s[0:1], 0
  s_load_dwordx2 s[60:61], s[0:1], 88
  v_lshrrev_b32 v2, 6, v0
  v_and_b32 v1, 63, v0
  s_and_b32 s76, s2, 7
  s_lshr_b32 s77, s2, 3
  v_readfirstlane_b32 s3, v2
  v_lshrrev_b32 v2, 3, v1
  v_and_b32 v3, 7, v1
  v_lshlrev_b32 v3, 4, v3
  s_xor_b32 s3, s3, 6
  s_cmp_lg_u32 s3, 7
  s_cbranch_scc1 L_nopre
  s_getpc_b64 s[20:21]
L_pc:
  s_sub_u32 s20, s20, L_pc-parallel_sum__sliding_block_cached__glu_gated_geglu__decode_kernel
  s_subb_u32 s21, s21, 0
  v_lshlrev_b32 v253, 7, v1
  global_load_dword v254, v253, s[20:21]
  v_add_u32 v253, 0x2000, v253
  v_min_u32 v253, L_end-parallel_sum__sliding_block_cached__glu_gated_geglu__decode_kernel, v253
  global_load_dword v255, v253, s[20:21]
L_nopre:
  s_and_b32 s78, s77, 3
  s_cbranch_scc1 L_P
  s_mov_b32 s54, 0x2000000
  s_mov_b32 s55, 0x20000
  s_lshl_b32 s6, s77, 1
  s_add_u32 s6, s6, s76
  s_lshr_b32 s4, s6, 4
  s_and_b32 s5, s6, 15
  s_lshl_b32 s6, s4, 23
  s_lshl_b32 s7, s5, 16
  s_add_u32 s6, s6, s7
  s_lshl_b32 s7, s3, 13
  s_add_u32 s6, s6, s7
  s_add_u32 s6, s6, 7340032
  v_lshrrev_b32 v5, 4, v1
  v_and_b32 v6, 15, v1
  v_lshlrev_b32 v7, 8, v5
  v_add_u32 v15, 0, v5
  v_xor_b32 v15, v15, v6
  v_lshl_add_u32 v224, v15, 4, v7
  v_add_u32 v15, 4, v5
  v_xor_b32 v15, v15, v6
  v_lshl_add_u32 v225, v15, 4, v7
  v_add_u32 v15, 8, v5
  v_xor_b32 v15, v15, v6
  v_lshl_add_u32 v226, v15, 4, v7
  v_add_u32 v15, 12, v5
  v_xor_b32 v15, v15, v6
  v_lshl_add_u32 v227, v15, 4, v7
  s_add_u32 s8, s7, 16384
  s_add_u32 s9, s6, 4096
  s_mov_b32 m0, s8
  s_waitcnt lgkmcnt(0)
  buffer_load_dwordx4 v224, s[52:55], s6 offen offset:0 nt lds
  buffer_load_dwordx4 v225, s[52:55], s6 offen offset:1024 nt lds
  buffer_load_dwordx4 v226, s[52:55], s6 offen offset:2048 nt lds
  buffer_load_dwordx4 v227, s[52:55], s6 offen offset:3072 nt lds
  s_add_u32 m0, s8, 4096
  s_nop 0
  buffer_load_dwordx4 v224, s[52:55], s9 offen offset:0 nt lds
  buffer_load_dwordx4 v225, s[52:55], s9 offen offset:1024 nt lds
  buffer_load_dwordx4 v226, s[52:55], s9 offen offset:2048 nt lds
  buffer_load_dwordx4 v227, s[52:55], s9 offen offset:3072 nt lds
  s_branch L_A2
L_P:
  s_lshr_b32 s73, s77, 2
  s_sub_u32 s73, s77, s73
  s_sub_u32 s73, s73, 1
  s_lshl_b32 s73, s73, 3
  s_add_u32 s73, s73, s76
  s_mul_i32 s74, s73, 171
  s_lshr_b32 s74, s74, 9
  s_mul_i32 s75, s74, 3
  s_sub_u32 s75, s73, s75
  s_cmp_lg_u32 s3, 6
  s_cbranch_scc1 L_nx
  s_setprio 3
  s_mov_b32 s30, 0x800
  s_mov_b32 s31, 0x20000
  v_lshlrev_b32 v5, 5, v1
  v_lshlrev_b32 v6, 4, v1
  s_mul_i32 s4, s75, 704
  s_waitcnt lgkmcnt(0)
  buffer_load_dwordx4 v[16:19], v5, s[28:31], 0 offen
  buffer_load_dwordx4 v[20:23], v5, s[28:31], 0 offen offset:16
  buffer_load_dwordx4 v[24:27], v6, s[28:31], s4 offen
  s_branch L_PLN
L_nx:
  s_cmp_ge_u32 s3, 4
  s_cbranch_scc1 L_Pcomm
  s_mov_b32 s34, 0x800000
  s_mov_b32 s35, 0x20000
  s_mul_i32 s6, s75, 352
  s_mul_i32 s7, s3, 88
  s_add_u32 s6, s6, s7
  s_xor_b32 s7, s74, 0
  s_lshl_b32 s7, s7, 7
  s_lshl_b32 s4, s6, 13
  s_add_u32 s4, s4, s7
  v_lshl_add_u32 v12, v2, 13, v3
  s_waitcnt lgkmcnt(0)
  buffer_load_dwordx4 v[176:179], v12, s[32:35], s4 offen nt
  s_add_u32 s4, s4, 65536
  buffer_load_dwordx4 v[180:183], v12, s[32:35], s4 offen nt
  s_add_u32 s4, s4, 65536
  buffer_load_dwordx4 v[184:187], v12, s[32:35], s4 offen nt
  s_add_u32 s4, s4, 65536
  buffer_load_dwordx4 v[188:191], v12, s[32:35], s4 offen nt
  s_add_u32 s4, s4, 65536
  buffer_load_dwordx4 v[192:195], v12, s[32:35], s4 offen nt
  s_add_u32 s4, s4, 65536
  buffer_load_dwordx4 v[196:199], v12, s[32:35], s4 offen nt
  s_add_u32 s4, s4, 65536
  s_and_b32 s8, s74, 7
  s_cmp_eq_u32 s8, 3
  s_cbranch_scc1 L_PF
  s_cmp_ge_u32 s74, 56
  s_cbranch_scc1 L_PF
  s_load_dword s69, s[60:61], 0
  s_load_dwordx2 s[36:37], s[0:1], 48
  s_load_dwordx2 s[40:41], s[0:1], 56
  s_load_dwordx2 s[44:45], s[0:1], 32
  s_load_dwordx2 s[48:49], s[0:1], 64
  s_mov_b32 s62, 0x200000
  s_mov_b32 s63, 0x20000
  v_mov_b32 v4, 0xfffff000
  s_mov_b32 s70, 300000
  s_getpc_b64 s[22:23]
L_pt1:
  s_and_b32 s24, s73, 0xfc
  s_add_u32 s24, s24, L_tiles-L_pt1
  s_load_dword s71, s[22:23], s24
  s_sub_u32 s8, s74, 56
  s_lshl_b32 s8, s8, 3
  s_add_u32 s8, s8, 3
  s_and_b32 s10, s74, 7
  s_cmp_lg_u32 s10, 3
  s_cselect_b32 s10, 1, 0
  s_cmp_lt_u32 s74, 56
  s_cselect_b32 s8, s74, s8
  s_cselect_b32 s9, 1, 0
  s_cselect_b32 s10, s10, 1
  s_cmp_eq_u32 s74, 63
  s_cselect_b32 s10, 0, s10
  s_mul_i32 s38, s9, 7340032
  s_mul_i32 s42, s10, 7340032
  s_mov_b32 s39, 0x20000
  s_mov_b32 s43, 0x20000
  s_lshl_b32 s7, s8, 7
  s_mul_i32 s5, s6, 7168
  s_add_u32 s5, s5, s7
  v_mul_u32_u24 v13, 7168, v2
  v_add_u32 v13, v13, v3
  v_and_b32 v5, 1, v1
  v_lshlrev_b32 v5, 4, v5
  v_mov_b32 v6, 0xffff
  v_lshlrev_b32 v6, v5, v6
  v_bfe_u32 v5, v1, 1, 2
  v_cmp_eq_u32 vcc, 0, v5
  s_nop 1
  v_cndmask_b32 v8, 0, v6, vcc
  v_cmp_eq_u32 vcc, 1, v5
  s_nop 1
  v_cndmask_b32 v9, 0, v6, vcc
  v_cmp_eq_u32 vcc, 2, v5
  s_nop 1
  v_cndmask_b32 v10, 0, v6, vcc
  v_cmp_eq_u32 vcc, 3, v5
  s_nop 1
  v_cndmask_b32 v11, 0, v6, vcc
  v_mov_b32 v16, 0
  v_mov_b32 v17, 0
  v_mov_b32 v18, 0
  v_mov_b32 v19, 0
  v_mov_b32 v20, 0
  v_mov_b32 v21, 0
  v_mov_b32 v22, 0
  v_mov_b32 v23, 0
  v_mov_b32 v24, 0
  v_mov_b32 v25, 0
  v_mov_b32 v26, 0
  v_mov_b32 v27, 0
  v_mov_b32 v28, 0
  v_mov_b32 v29, 0
  v_mov_b32 v30, 0
  v_mov_b32 v31, 0
  v_lshlrev_b32 v5, 1, v3
  v_and_b32 v6, 16, v1
  v_add_u32 v5, v5, v6
  v_lshrrev_b32 v6, 5, v1
  v_lshl_add_u32 v5, v6, 8, v5
  s_lshl_b32 s7, s3, 9
  v_add_u32 v5, s7, v5
  s_mul_i32 s7, s3, 352
  v_lshlrev_b32 v6, 2, v2
  v_add_u32 v6, s7, v6
  s_waitcnt vmcnt(5)
  buffer_load_dwordx4 v[200:203], v12, s[32:35], s4 offen nt
  s_add_u32 s4, s4, 65536
  s_waitcnt vmcnt(5)
  buffer_load_dwordx4 v[204:207], v12, s[32:35], s4 offen nt
  s_add_u32 s4, s4, 65536
  s_waitcnt lgkmcnt(0)
  s_add_u32 s69, s69, 1
  s_and_b32 s68, s69, 0xfff
  s_and_b32 s27, s69, 0xff
  s_and_b32 s24, s73, 3
  s_lshl_b32 s24, s24, 3
  s_lshr_b32 s71, s71, s24
  s_and_b32 s71, s71, 0xff
  s_and_b32 s24, s3, 2
  s_lshl_b32 s24, s24, 1
  s_add_u32 s71, s71, s24
  s_and_b32 s76, s2, 7
  s_lshl_b32 s76, s76, 8
  s_and_b32 s77, s3, 1
  s_lshl_b32 s77, s77, 7
  s_add_u32 s76, s76, s77
  s_bfe_u32 s77, s71, 0x50002
  s_cmp_lt_u32 s71, 128
  s_cselect_b32 s78, 16, 20
  s_cselect_b32 s46, 8, 7
  s_cselect_b32 s44, s44, s48
  s_cselect_b32 s45, s45, s49
  s_lshl_b32 s46, s46, 20
  s_mov_b32 s47, 0x20000
  s_lshl_b32 s78, s78, 14
  s_mul_i32 s72, s77, s78
  s_add_u32 s72, s72, s76
  v_lshl_add_u32 v14, v2, 11, v3
  s_barrier
  ds_read2_b32 v[80:81], v6 offset0:0 offset1:8
  ds_read2_b32 v[82:83], v6 offset0:16 offset1:24
  ds_read2_b32 v[84:85], v6 offset0:32 offset1:40
  ds_read2_b32 v[86:87], v6 offset0:48 offset1:56
  ds_read2_b32 v[88:89], v6 offset0:64 offset1:72
  ds_read2_b32 v[90:91], v6 offset0:80 offset1:88
  s_waitcnt lgkmcnt(5)
  v_and_b32 v32, v80, v8
  v_and_b32 v33, v80, v9
  v_and_b32 v34, v80, v10
  v_and_b32 v35, v80, v11
  v_and_b32 v36, v81, v8
  v_and_b32 v37, v81, v9
  v_and_b32 v38, v81, v10
  v_and_b32 v39, v81, v11
  s_waitcnt lgkmcnt(4)
  v_and_b32 v40, v82, v8
  v_and_b32 v41, v82, v9
  v_and_b32 v42, v82, v10
  v_and_b32 v43, v82, v11
  v_and_b32 v44, v83, v8
  v_and_b32 v45, v83, v9
  v_and_b32 v46, v83, v10
  v_and_b32 v47, v83, v11
  s_waitcnt lgkmcnt(3)
  v_and_b32 v48, v84, v8
  v_and_b32 v49, v84, v9
  v_and_b32 v50, v84, v10
  v_and_b32 v51, v84, v11
  v_and_b32 v52, v85, v8
  v_and_b32 v53, v85, v9
  v_and_b32 v54, v85, v10
  v_and_b32 v55, v85, v11
  s_waitcnt lgkmcnt(2)
  v_and_b32 v56, v86, v8
  v_and_b32 v57, v86, v9
  v_and_b32 v58, v86, v10
  v_and_b32 v59, v86, v11
  v_and_b32 v60, v87, v8
  v_and_b32 v61, v87, v9
  v_and_b32 v62, v87, v10
  v_and_b32 v63, v87, v11
  s_waitcnt lgkmcnt(1)
  v_and_b32 v64, v88, v8
  v_and_b32 v65, v88, v9
  v_and_b32 v66, v88, v10
  v_and_b32 v67, v88, v11
  v_and_b32 v68, v89, v8
  v_and_b32 v69, v89, v9
  v_and_b32 v70, v89, v10
  v_and_b32 v71, v89, v11
  s_waitcnt lgkmcnt(0)
  v_and_b32 v72, v90, v8
  v_and_b32 v73, v90, v9
  v_and_b32 v74, v90, v10
  v_and_b32 v75, v90, v11
  v_mfma_f32_16x16x32_bf16 v[16:19], v[32:35], v[176:179], v[16:19]
  v_mfma_f32_16x16x32_bf16 v[16:19], v[36:39], v[180:183], v[16:19]
  s_waitcnt vmcnt(5)
  buffer_load_dwordx4 v[208:211], v12, s[32:35], s4 offen nt
  s_add_u32 s4, s4, 65536
  v_mfma_f32_16x16x32_bf16 v[16:19], v[40:43], v[184:187], v[16:19]
  s_waitcnt vmcnt(5)
  buffer_load_dwordx4 v[212:215], v12, s[32:35], s4 offen nt
  s_add_u32 s4, s4, 65536
  v_mfma_f32_16x16x32_bf16 v[16:19], v[44:47], v[188:191], v[16:19]
  s_waitcnt vmcnt(5)
  buffer_load_dwordx4 v[216:219], v12, s[32:35], s4 offen nt
  s_add_u32 s4, s4, 65536
  buffer_load_dwordx4 v[220:223], v13, s[36:39], s5 offen nt
  v_mfma_f32_16x16x32_bf16 v[16:19], v[48:51], v[192:195], v[16:19]
  s_waitcnt vmcnt(6)
  buffer_load_dwordx4 v[224:227], v13, s[40:43], s5 offen nt
  s_add_u32 s5, s5, 57344
  v_mfma_f32_16x16x32_bf16 v[16:19], v[52:55], v[196:199], v[16:19]
  s_waitcnt vmcnt(6)
  buffer_load_dwordx4 v[228:231], v13, s[36:39], s5 offen nt
  v_mfma_f32_16x16x32_bf16 v[16:19], v[56:59], v[200:203], v[16:19]
  s_waitcnt vmcnt(6)
  buffer_load_dwordx4 v[232:235], v13, s[40:43], s5 offen nt
  s_add_u32 s5, s5, 57344
  v_mfma_f32_16x16x32_bf16 v[16:19], v[60:63], v[204:207], v[16:19]
  s_waitcnt vmcnt(6)
  buffer_load_dwordx4 v[236:239], v13, s[36:39], s5 offen nt
  v_mfma_f32_16x16x32_bf16 v[16:19], v[64:67], v[208:211], v[16:19]
  s_waitcnt vmcnt(6)
  buffer_load_dwordx4 v[240:243], v13, s[40:43], s5 offen nt
  s_add_u32 s5, s5, 57344
  v_mfma_f32_16x16x32_bf16 v[16:19], v[68:71], v[212:215], v[16:19]
  s_waitcnt vmcnt(6)
  v_mfma_f32_16x16x32_bf16 v[16:19], v[72:75], v[216:219], v[16:19]
  s_mov_b32 exec_lo, 0xff00ff
  s_mov_b32 exec_hi, 0xff00ff00
  s_nop 6
  ds_write_b128 v5, v[16:19] offset:4096
  s_mov_b64 exec, -1
  buffer_load_dwordx4 v[244:247], v13, s[36:39], s5 offen nt
  s_waitcnt lgkmcnt(0)
  s_barrier
  s_waitcnt vmcnt(6)
  buffer_load_dwordx4 v[248:251], v13, s[40:43], s5 offen nt
  s_add_u32 s5, s5, 57344
  v_mfma_f32_16x16x32_bf16 v[20:23], v[32:35], v[220:223], v[20:23]
  s_waitcnt vmcnt(6)
  buffer_load_dwordx4 v[176:179], v13, s[36:39], s5 offen nt
  v_mfma_f32_16x16x32_bf16 v[24:27], v[32:35], v[224:227], v[24:27]
  s_waitcnt vmcnt(6)
  buffer_load_dwordx4 v[180:183], v13, s[40:43], s5 offen nt
  s_add_u32 s5, s5, 57344
  v_mfma_f32_16x16x32_bf16 v[20:23], v[36:39], v[228:231], v[20:23]
  s_waitcnt vmcnt(6)
  buffer_load_dwordx4 v[184:187], v13, s[36:39], s5 offen nt
  v_mfma_f32_16x16x32_bf16 v[24:27], v[36:39], v[232:235], v[24:27]
  s_waitcnt vmcnt(6)
  buffer_load_dwordx4 v[188:191], v13, s[40:43], s5 offen nt
  s_add_u32 s5, s5, 57344
  v_mfma_f32_16x16x32_bf16 v[20:23], v[40:43], v[236:239], v[20:23]
  s_waitcnt vmcnt(6)
  buffer_load_dwordx4 v[192:195], v13, s[36:39], s5 offen nt
  v_mfma_f32_16x16x32_bf16 v[24:27], v[40:43], v[240:243], v[24:27]
  s_waitcnt vmcnt(6)
  buffer_load_dwordx4 v[196:199], v13, s[40:43], s5 offen nt
  s_add_u32 s5, s5, 57344
  v_mfma_f32_16x16x32_bf16 v[20:23], v[44:47], v[244:247], v[20:23]
  s_waitcnt vmcnt(6)
  buffer_load_dwordx4 v[200:203], v13, s[36:39], s5 offen nt
  v_mfma_f32_16x16x32_bf16 v[24:27], v[44:47], v[248:251], v[24:27]
  s_waitcnt vmcnt(6)
  buffer_load_dwordx4 v[204:207], v13, s[40:43], s5 offen nt
  s_add_u32 s5, s5, 57344
  v_mfma_f32_16x16x32_bf16 v[20:23], v[48:51], v[176:179], v[20:23]
  s_waitcnt vmcnt(6)
  buffer_load_dwordx4 v[208:211], v13, s[36:39], s5 offen nt
  v_mfma_f32_16x16x32_bf16 v[24:27], v[48:51], v[180:183], v[24:27]
  s_waitcnt vmcnt(6)
  buffer_load_dwordx4 v[212:215], v13, s[40:43], s5 offen nt
  s_add_u32 s5, s5, 57344
  v_mfma_f32_16x16x32_bf16 v[20:23], v[52:55], v[184:187], v[20:23]
  s_waitcnt vmcnt(6)
  buffer_load_dwordx4 v[216:219], v13, s[36:39], s5 offen nt
  v_mfma_f32_16x16x32_bf16 v[24:27], v[52:55], v[188:191], v[24:27]
  s_waitcnt vmcnt(6)
  buffer_load_dwordx4 v[220:223], v13, s[40:43], s5 offen nt
  s_add_u32 s5, s5, 57344
  v_mfma_f32_16x16x32_bf16 v[20:23], v[56:59], v[192:195], v[20:23]
  s_waitcnt vmcnt(6)
  buffer_load_dwordx4 v[224:227], v13, s[36:39], s5 offen nt
  v_mfma_f32_16x16x32_bf16 v[24:27], v[56:59], v[196:199], v[24:27]
  s_waitcnt vmcnt(6)
  buffer_load_dwordx4 v[228:231], v13, s[40:43], s5 offen nt
  s_add_u32 s5, s5, 57344
  v_mfma_f32_16x16x32_bf16 v[20:23], v[60:63], v[200:203], v[20:23]
  s_waitcnt vmcnt(6)
  v_mfma_f32_16x16x32_bf16 v[24:27], v[60:63], v[204:207], v[24:27]
  s_waitcnt vmcnt(5)
  buffer_load_dwordx4 v[96:99], v14, s[44:47], s72 offen nt
  s_add_u32 s72, s72, 16384
  v_mfma_f32_16x16x32_bf16 v[20:23], v[64:67], v[208:211], v[20:23]
  s_waitcnt vmcnt(5)
  buffer_load_dwordx4 v[100:103], v14, s[44:47], s72 offen nt
  s_add_u32 s72, s72, 16384
  v_mfma_f32_16x16x32_bf16 v[24:27], v[64:67], v[212:215], v[24:27]
  s_waitcnt vmcnt(5)
  buffer_load_dwordx4 v[104:107], v14, s[44:47], s72 offen nt
  s_add_u32 s72, s72, 16384
  v_mfma_f32_16x16x32_bf16 v[20:23], v[68:71], v[216:219], v[20:23]
  s_waitcnt vmcnt(5)
  buffer_load_dwordx4 v[108:111], v14, s[44:47], s72 offen nt
  s_add_u32 s72, s72, 16384
  v_mfma_f32_16x16x32_bf16 v[24:27], v[68:71], v[220:223], v[24:27]
  s_waitcnt vmcnt(5)
  buffer_load_dwordx4 v[112:115], v14, s[44:47], s72 offen nt
  s_add_u32 s72, s72, 16384
  v_mfma_f32_16x16x32_bf16 v[20:23], v[72:75], v[224:227], v[20:23]
  s_waitcnt vmcnt(5)
  v_mfma_f32_16x16x32_bf16 v[24:27], v[72:75], v[228:231], v[24:27]
  s_mov_b32 exec_lo, 0xff00ff
  s_mov_b32 exec_hi, 0xff00ff00
  s_nop 6
  ds_write_b128 v5, v[20:23] offset:6144
  ds_write_b128 v5, v[24:27] offset:8192
  s_mov_b64 exec, -1
  buffer_load_dwordx4 v[116:119], v14, s[44:47], s72 offen nt
  s_add_u32 s72, s72, 16384
  s_waitcnt lgkmcnt(0)
  s_barrier
  s_branch L_tail
L_PF:
  buffer_load_dwordx4 v[200:203], v12, s[32:35], s4 offen nt
  s_add_u32 s4, s4, 65536
  buffer_load_dwordx4 v[204:207], v12, s[32:35], s4 offen nt
  s_add_u32 s4, s4, 65536
  buffer_load_dwordx4 v[208:211], v12, s[32:35], s4 offen nt
  s_add_u32 s4, s4, 65536
  buffer_load_dwordx4 v[212:215], v12, s[32:35], s4 offen nt
  s_add_u32 s4, s4, 65536
  buffer_load_dwordx4 v[216:219], v12, s[32:35], s4 offen nt
  s_add_u32 s4, s4, 65536
  s_load_dword s69, s[60:61], 0
  s_load_dwordx2 s[36:37], s[0:1], 48
  s_load_dwordx2 s[40:41], s[0:1], 56
  s_load_dwordx2 s[44:45], s[0:1], 32
  s_load_dwordx2 s[48:49], s[0:1], 64
  s_mov_b32 s62, 0x200000
  s_mov_b32 s63, 0x20000
  v_mov_b32 v4, 0xfffff000
  s_mov_b32 s70, 300000
  s_getpc_b64 s[22:23]
L_pt2:
  s_and_b32 s24, s73, 0xfc
  s_add_u32 s24, s24, L_tiles-L_pt2
  s_load_dword s71, s[22:23], s24
  s_sub_u32 s8, s74, 56
  s_lshl_b32 s8, s8, 3
  s_add_u32 s8, s8, 3
  s_and_b32 s10, s74, 7
  s_cmp_lg_u32 s10, 3
  s_cselect_b32 s10, 1, 0
  s_cmp_lt_u32 s74, 56
  s_cselect_b32 s8, s74, s8
  s_cselect_b32 s9, 1, 0
  s_cselect_b32 s10, s10, 1
  s_cmp_eq_u32 s74, 63
  s_cselect_b32 s10, 0, s10
  s_mul_i32 s38, s9, 7340032
  s_mul_i32 s42, s10, 7340032
  s_mov_b32 s39, 0x20000
  s_mov_b32 s43, 0x20000
  s_lshl_b32 s7, s8, 7
  s_mul_i32 s5, s6, 7168
  s_add_u32 s5, s5, s7
  v_mul_u32_u24 v13, 7168, v2
  v_add_u32 v13, v13, v3
  v_and_b32 v5, 1, v1
  v_lshlrev_b32 v5, 4, v5
  v_mov_b32 v6, 0xffff
  v_lshlrev_b32 v6, v5, v6
  v_bfe_u32 v5, v1, 1, 2
  v_cmp_eq_u32 vcc, 0, v5
  s_nop 1
  v_cndmask_b32 v8, 0, v6, vcc
  v_cmp_eq_u32 vcc, 1, v5
  s_nop 1
  v_cndmask_b32 v9, 0, v6, vcc
  v_cmp_eq_u32 vcc, 2, v5
  s_nop 1
  v_cndmask_b32 v10, 0, v6, vcc
  v_cmp_eq_u32 vcc, 3, v5
  s_nop 1
  v_cndmask_b32 v11, 0, v6, vcc
  v_mov_b32 v16, 0
  v_mov_b32 v17, 0
  v_mov_b32 v18, 0
  v_mov_b32 v19, 0
  v_mov_b32 v20, 0
  v_mov_b32 v21, 0
  v_mov_b32 v22, 0
  v_mov_b32 v23, 0
  v_mov_b32 v24, 0
  v_mov_b32 v25, 0
  v_mov_b32 v26, 0
  v_mov_b32 v27, 0
  v_mov_b32 v28, 0
  v_mov_b32 v29, 0
  v_mov_b32 v30, 0
  v_mov_b32 v31, 0
  v_lshlrev_b32 v5, 1, v3
  v_and_b32 v6, 16, v1
  v_add_u32 v5, v5, v6
  v_lshrrev_b32 v6, 5, v1
  v_lshl_add_u32 v5, v6, 8, v5
  s_lshl_b32 s7, s3, 9
  v_add_u32 v5, s7, v5
  s_mul_i32 s7, s3, 352
  v_lshlrev_b32 v6, 2, v2
  v_add_u32 v6, s7, v6
  s_waitcnt lgkmcnt(0)
  s_add_u32 s69, s69, 1
  s_and_b32 s68, s69, 0xfff
  s_and_b32 s27, s69, 0xff
  s_and_b32 s24, s73, 3
  s_lshl_b32 s24, s24, 3
  s_lshr_b32 s71, s71, s24
  s_and_b32 s71, s71, 0xff
  s_and_b32 s24, s3, 2
  s_lshl_b32 s24, s24, 1
  s_add_u32 s71, s71, s24
  s_and_b32 s76, s2, 7
  s_lshl_b32 s76, s76, 8
  s_and_b32 s77, s3, 1
  s_lshl_b32 s77, s77, 7
  s_add_u32 s76, s76, s77
  s_bfe_u32 s77, s71, 0x50002
  s_cmp_lt_u32 s71, 128
  s_cselect_b32 s78, 16, 20
  s_cselect_b32 s46, 8, 7
  s_cselect_b32 s44, s44, s48
  s_cselect_b32 s45, s45, s49
  s_lshl_b32 s46, s46, 20
  s_mov_b32 s47, 0x20000
  s_lshl_b32 s78, s78, 14
  s_mul_i32 s72, s77, s78
  s_add_u32 s72, s72, s76
  v_lshl_add_u32 v14, v2, 11, v3
  s_barrier
  ds_read2_b32 v[80:81], v6 offset0:0 offset1:8
  ds_read2_b32 v[82:83], v6 offset0:16 offset1:24
  ds_read2_b32 v[84:85], v6 offset0:32 offset1:40
  ds_read2_b32 v[86:87], v6 offset0:48 offset1:56
  ds_read2_b32 v[88:89], v6 offset0:64 offset1:72
  ds_read2_b32 v[90:91], v6 offset0:80 offset1:88
  s_waitcnt lgkmcnt(5)
  v_and_b32 v32, v80, v8
  v_and_b32 v33, v80, v9
  v_and_b32 v34, v80, v10
  v_and_b32 v35, v80, v11
  v_and_b32 v36, v81, v8
  v_and_b32 v37, v81, v9
  v_and_b32 v38, v81, v10
  v_and_b32 v39, v81, v11
  s_waitcnt lgkmcnt(4)
  v_and_b32 v40, v82, v8
  v_and_b32 v41, v82, v9
  v_and_b32 v42, v82, v10
  v_and_b32 v43, v82, v11
  v_and_b32 v44, v83, v8
  v_and_b32 v45, v83, v9
  v_and_b32 v46, v83, v10
  v_and_b32 v47, v83, v11
  s_waitcnt lgkmcnt(3)
  v_and_b32 v48, v84, v8
  v_and_b32 v49, v84, v9
  v_and_b32 v50, v84, v10
  v_and_b32 v51, v84, v11
  v_and_b32 v52, v85, v8
  v_and_b32 v53, v85, v9
  v_and_b32 v54, v85, v10
  v_and_b32 v55, v85, v11
  s_waitcnt lgkmcnt(2)
  v_and_b32 v56, v86, v8
  v_and_b32 v57, v86, v9
  v_and_b32 v58, v86, v10
  v_and_b32 v59, v86, v11
  v_and_b32 v60, v87, v8
  v_and_b32 v61, v87, v9
  v_and_b32 v62, v87, v10
  v_and_b32 v63, v87, v11
  s_waitcnt lgkmcnt(1)
  v_and_b32 v64, v88, v8
  v_and_b32 v65, v88, v9
  v_and_b32 v66, v88, v10
  v_and_b32 v67, v88, v11
  v_and_b32 v68, v89, v8
  v_and_b32 v69, v89, v9
  v_and_b32 v70, v89, v10
  v_and_b32 v71, v89, v11
  s_waitcnt lgkmcnt(0)
  v_and_b32 v72, v90, v8
  v_and_b32 v73, v90, v9
  v_and_b32 v74, v90, v10
  v_and_b32 v75, v90, v11
  s_waitcnt vmcnt(10)
  v_mfma_f32_16x16x32_bf16 v[16:19], v[32:35], v[176:179], v[16:19]
  s_waitcnt vmcnt(9)
  v_mfma_f32_16x16x32_bf16 v[16:19], v[36:39], v[180:183], v[16:19]
  s_waitcnt vmcnt(8)
  v_mfma_f32_16x16x32_bf16 v[16:19], v[40:43], v[184:187], v[16:19]
  s_waitcnt vmcnt(7)
  v_mfma_f32_16x16x32_bf16 v[16:19], v[44:47], v[188:191], v[16:19]
  s_waitcnt vmcnt(6)
  v_mfma_f32_16x16x32_bf16 v[16:19], v[48:51], v[192:195], v[16:19]
  s_waitcnt vmcnt(5)
  v_mfma_f32_16x16x32_bf16 v[16:19], v[52:55], v[196:199], v[16:19]
  s_waitcnt vmcnt(4)
  buffer_load_dwordx4 v[220:223], v13, s[36:39], s5 offen nt
  v_mfma_f32_16x16x32_bf16 v[16:19], v[56:59], v[200:203], v[16:19]
  s_waitcnt vmcnt(4)
  buffer_load_dwordx4 v[224:227], v13, s[40:43], s5 offen nt
  s_add_u32 s5, s5, 57344
  v_mfma_f32_16x16x32_bf16 v[16:19], v[60:63], v[204:207], v[16:19]
  s_waitcnt vmcnt(4)
  buffer_load_dwordx4 v[228:231], v13, s[36:39], s5 offen nt
  v_mfma_f32_16x16x32_bf16 v[16:19], v[64:67], v[208:211], v[16:19]
  s_waitcnt vmcnt(4)
  buffer_load_dwordx4 v[232:235], v13, s[40:43], s5 offen nt
  s_add_u32 s5, s5, 57344
  v_mfma_f32_16x16x32_bf16 v[16:19], v[68:71], v[212:215], v[16:19]
  s_waitcnt vmcnt(4)
  v_mfma_f32_16x16x32_bf16 v[16:19], v[72:75], v[216:219], v[16:19]
  s_mov_b32 exec_lo, 0xff00ff
  s_mov_b32 exec_hi, 0xff00ff00
  s_nop 6
  ds_write_b128 v5, v[16:19] offset:4096
  s_mov_b64 exec, -1
  buffer_load_dwordx4 v[236:239], v13, s[36:39], s5 offen nt
  s_waitcnt lgkmcnt(0)
  s_barrier
  s_waitcnt vmcnt(4)
  buffer_load_dwordx4 v[240:243], v13, s[40:43], s5 offen nt
  s_add_u32 s5, s5, 57344
  v_mfma_f32_16x16x32_bf16 v[20:23], v[32:35], v[220:223], v[20:23]
  s_waitcnt vmcnt(4)
  buffer_load_dwordx4 v[244:247], v13, s[36:39], s5 offen nt
  buffer_load_dwordx4 v[248:251], v13, s[40:43], s5 offen nt
  s_add_u32 s5, s5, 57344
  buffer_load_dwordx4 v[176:179], v13, s[36:39], s5 offen nt
  buffer_load_dwordx4 v[180:183], v13, s[40:43], s5 offen nt
  s_add_u32 s5, s5, 57344
  buffer_load_dwordx4 v[184:187], v13, s[36:39], s5 offen nt
  buffer_load_dwordx4 v[188:191], v13, s[40:43], s5 offen nt
  s_add_u32 s5, s5, 57344
  buffer_load_dwordx4 v[192:195], v13, s[36:39], s5 offen nt
  buffer_load_dwordx4 v[196:199], v13, s[40:43], s5 offen nt
  s_add_u32 s5, s5, 57344
  v_mfma_f32_16x16x32_bf16 v[24:27], v[32:35], v[224:227], v[24:27]
  s_waitcnt vmcnt(11)
  buffer_load_dwordx4 v[200:203], v13, s[36:39], s5 offen nt
  v_mfma_f32_16x16x32_bf16 v[20:23], v[36:39], v[228:231], v[20:23]
  s_waitcnt vmcnt(11)
  buffer_load_dwordx4 v[204:207], v13, s[40:43], s5 offen nt
  s_add_u32 s5, s5, 57344
  v_mfma_f32_16x16x32_bf16 v[24:27], v[36:39], v[232:235], v[24:27]
  s_waitcnt vmcnt(11)
  buffer_load_dwordx4 v[208:211], v13, s[36:39], s5 offen nt
  v_mfma_f32_16x16x32_bf16 v[20:23], v[40:43], v[236:239], v[20:23]
  s_waitcnt vmcnt(11)
  buffer_load_dwordx4 v[212:215], v13, s[40:43], s5 offen nt
  s_add_u32 s5, s5, 57344
  v_mfma_f32_16x16x32_bf16 v[24:27], v[40:43], v[240:243], v[24:27]
  s_waitcnt vmcnt(11)
  buffer_load_dwordx4 v[216:219], v13, s[36:39], s5 offen nt
  v_mfma_f32_16x16x32_bf16 v[20:23], v[44:47], v[244:247], v[20:23]
  s_waitcnt vmcnt(11)
  buffer_load_dwordx4 v[220:223], v13, s[40:43], s5 offen nt
  s_add_u32 s5, s5, 57344
  v_mfma_f32_16x16x32_bf16 v[24:27], v[44:47], v[248:251], v[24:27]
  s_waitcnt vmcnt(11)
  buffer_load_dwordx4 v[224:227], v13, s[36:39], s5 offen nt
  v_mfma_f32_16x16x32_bf16 v[20:23], v[48:51], v[176:179], v[20:23]
  s_waitcnt vmcnt(11)
  buffer_load_dwordx4 v[228:231], v13, s[40:43], s5 offen nt
  s_add_u32 s5, s5, 57344
  v_mfma_f32_16x16x32_bf16 v[24:27], v[48:51], v[180:183], v[24:27]
  s_waitcnt vmcnt(11)
  v_mfma_f32_16x16x32_bf16 v[20:23], v[52:55], v[184:187], v[20:23]
  s_waitcnt vmcnt(10)
  v_mfma_f32_16x16x32_bf16 v[24:27], v[52:55], v[188:191], v[24:27]
  s_waitcnt vmcnt(9)
  v_mfma_f32_16x16x32_bf16 v[20:23], v[56:59], v[192:195], v[20:23]
  s_waitcnt vmcnt(8)
  v_mfma_f32_16x16x32_bf16 v[24:27], v[56:59], v[196:199], v[24:27]
  s_waitcnt vmcnt(7)
  v_mfma_f32_16x16x32_bf16 v[20:23], v[60:63], v[200:203], v[20:23]
  s_waitcnt vmcnt(6)
  v_mfma_f32_16x16x32_bf16 v[24:27], v[60:63], v[204:207], v[24:27]
  s_waitcnt vmcnt(5)
  buffer_load_dwordx4 v[96:99], v14, s[44:47], s72 offen nt
  s_add_u32 s72, s72, 16384
  v_mfma_f32_16x16x32_bf16 v[20:23], v[64:67], v[208:211], v[20:23]
  s_waitcnt vmcnt(5)
  buffer_load_dwordx4 v[100:103], v14, s[44:47], s72 offen nt
  s_add_u32 s72, s72, 16384
  v_mfma_f32_16x16x32_bf16 v[24:27], v[64:67], v[212:215], v[24:27]
  s_waitcnt vmcnt(5)
  buffer_load_dwordx4 v[104:107], v14, s[44:47], s72 offen nt
  s_add_u32 s72, s72, 16384
  v_mfma_f32_16x16x32_bf16 v[20:23], v[68:71], v[216:219], v[20:23]
  s_waitcnt vmcnt(5)
  buffer_load_dwordx4 v[108:111], v14, s[44:47], s72 offen nt
  s_add_u32 s72, s72, 16384
  v_mfma_f32_16x16x32_bf16 v[24:27], v[68:71], v[220:223], v[24:27]
  s_waitcnt vmcnt(5)
  buffer_load_dwordx4 v[112:115], v14, s[44:47], s72 offen nt
  s_add_u32 s72, s72, 16384
  v_mfma_f32_16x16x32_bf16 v[20:23], v[72:75], v[224:227], v[20:23]
  s_waitcnt vmcnt(5)
  v_mfma_f32_16x16x32_bf16 v[24:27], v[72:75], v[228:231], v[24:27]
  s_mov_b32 exec_lo, 0xff00ff
  s_mov_b32 exec_hi, 0xff00ff00
  s_nop 6
  ds_write_b128 v5, v[20:23] offset:6144
  ds_write_b128 v5, v[24:27] offset:8192
  s_mov_b64 exec, -1
  buffer_load_dwordx4 v[116:119], v14, s[44:47], s72 offen nt
  s_add_u32 s72, s72, 16384
  s_waitcnt lgkmcnt(0)
  s_barrier
  s_branch L_tail
L_Pcomm:
  s_setprio 2
  s_mov_b32 s62, 0x200000
  s_mov_b32 s63, 0x20000
  v_mov_b32 v4, 0xfffff000
  s_mov_b32 s70, 300000
  s_getpc_b64 s[22:23]
L_pt3:
  s_and_b32 s24, s73, 0xfc
  s_add_u32 s24, s24, L_tiles-L_pt3
  s_load_dword s71, s[22:23], s24
  s_waitcnt lgkmcnt(0)
  s_load_dword s69, s[60:61], 0
  s_and_b32 s24, s73, 3
  s_lshl_b32 s24, s24, 3
  s_lshr_b32 s71, s71, s24
  s_and_b32 s71, s71, 0xff
  s_and_b32 s24, s3, 2
  s_lshl_b32 s24, s24, 1
  s_add_u32 s71, s71, s24
  s_cmp_eq_u32 s3, 5
  s_cbranch_scc1 L_P5
  s_cmp_lg_u32 s3, 7
  s_cbranch_scc1 L_P4
  s_waitcnt lgkmcnt(0)
  s_add_u32 s69, s69, 1
  s_and_b32 s68, s69, 0xfff
  s_and_b32 s27, s69, 0xff
  s_barrier
  s_barrier
  s_and_b32 s4, s2, 7
  s_lshl_b32 s4, s4, 10
  s_add_u32 s4, s4, 131072
  v_lshlrev_b32 v20, 3, v3
  buffer_load_dwordx4 v[16:19], v20, s[60:63], s4 offen sc1
  s_waitcnt vmcnt(0)
  s_getreg_b32 s4, hwreg(HW_REG_XCC_ID, 0, 4)
  s_lshl_b32 s4, s4, 12
  s_or_b32 s4, s4, s68
  v_xor_b32 v16, s4, v16
  v_xor_b32 v17, s4, v17
  v_xor_b32 v18, s4, v18
  v_xor_b32 v19, s4, v19
  v_or3_b32 v16, v16, v17, v18
  v_or_b32 v16, v16, v19
  v_cmp_ne_u32 vcc, 0, v16
  s_cmp_eq_u64 vcc, 0
  s_cselect_b32 s4, 1, 0
  v_mov_b32 v16, s4
  v_mov_b32 v20, 13856
  ds_write_b32 v20, v16
  s_waitcnt lgkmcnt(0)
  s_barrier
  s_branch L_comm
L_P4:
  v_and_b32 v5, 15, v1
  v_lshlrev_b32 v5, 4, v5
  v_lshrrev_b32 v6, 4, v1
  v_lshl_add_u32 v6, v6, 16, v5
  s_lshl_b32 s4, s75, 14
  s_xor_b32 s5, s74, 0
  s_lshl_b32 s5, s5, 8
  s_add_u32 s4, s4, s5
  s_add_u32 s4, s4, 786432
  v_mov_b32 v7, 0xffffff00
  s_waitcnt lgkmcnt(0)
  s_add_u32 s69, s69, 1
  s_and_b32 s68, s69, 0xfff
  s_and_b32 s27, s69, 0xff
  s_barrier
  s_barrier
  s_mov_b64 exec, 0xffff
  ds_read_b128 v[16:19], v5 offset:4096
  ds_read_b128 v[20:23], v5 offset:4352
  ds_read_b128 v[24:27], v5 offset:4608
  ds_read_b128 v[28:31], v5 offset:4864
  ds_read_b128 v[32:35], v5 offset:5120
  ds_read_b128 v[36:39], v5 offset:5376
  ds_read_b128 v[40:43], v5 offset:5632
  ds_read_b128 v[44:47], v5 offset:5888
  s_waitcnt lgkmcnt(6)
  v_pk_add_f32 v[16:17], v[16:17], v[20:21]
  v_pk_add_f32 v[18:19], v[18:19], v[22:23]
  s_waitcnt lgkmcnt(4)
  v_pk_add_f32 v[24:25], v[24:25], v[28:29]
  v_pk_add_f32 v[26:27], v[26:27], v[30:31]
  v_pk_add_f32 v[16:17], v[16:17], v[24:25]
  v_pk_add_f32 v[18:19], v[18:19], v[26:27]
  s_waitcnt lgkmcnt(2)
  v_pk_add_f32 v[32:33], v[32:33], v[36:37]
  v_pk_add_f32 v[34:35], v[34:35], v[38:39]
  v_pk_add_f32 v[16:17], v[16:17], v[32:33]
  v_pk_add_f32 v[18:19], v[18:19], v[34:35]
  s_waitcnt lgkmcnt(0)
  v_pk_add_f32 v[40:41], v[40:41], v[44:45]
  v_pk_add_f32 v[42:43], v[42:43], v[46:47]
  v_pk_add_f32 v[16:17], v[16:17], v[40:41]
  v_pk_add_f32 v[18:19], v[18:19], v[42:43]
  v_add_u32 v16, 0x80, v16
  v_add_u32 v17, 0x80, v17
  v_add_u32 v18, 0x80, v18
  v_add_u32 v19, 0x80, v19
  v_and_or_b32 v16, v16, v7, s27
  v_and_or_b32 v17, v17, v7, s27
  v_and_or_b32 v18, v18, v7, s27
  v_and_or_b32 v19, v19, v7, s27
  buffer_store_dwordx4 v[16:19], v6, s[60:63], s4 offen sc1
  s_mov_b64 exec, -1
  s_barrier
  s_branch L_comm
L_P5:
  s_sub_u32 s8, s74, 56
  s_lshl_b32 s8, s8, 3
  s_add_u32 s8, s8, 3
  s_and_b32 s10, s74, 7
  s_cmp_lg_u32 s10, 3
  s_cselect_b32 s10, 1, 0
  s_cmp_lt_u32 s74, 56
  s_cselect_b32 s8, s74, s8
  s_cselect_b32 s9, 1, 0
  s_cselect_b32 s10, s10, 1
  s_cmp_eq_u32 s74, 63
  s_cselect_b32 s10, 0, s10
  v_and_b32 v6, 15, v1
  v_lshlrev_b32 v6, 4, v6
  v_bfe_u32 v7, v1, 4, 1
  v_lshl_add_u32 v5, v7, 11, v6
  v_mul_u32_u24 v7, 14336, v7
  v_add_u32 v6, v6, v7
  v_lshrrev_b32 v7, 5, v1
  v_lshl_add_u32 v6, v7, 17, v6
  s_mul_i32 s4, s75, 28672
  s_lshl_b32 s5, s8, 8
  s_add_u32 s4, s4, s5
  s_add_u32 s4, s4, 1310720
  s_mul_i32 s9, s9, 0xffff
  s_mul_i32 s10, s10, 0xffff0000
  s_or_b32 s9, s9, s10
  s_waitcnt lgkmcnt(0)
  s_add_u32 s69, s69, 1
  s_and_b32 s68, s69, 0xfff
  s_and_b32 s27, s69, 0xff
  s_barrier
  s_barrier
  s_barrier
  s_cmp_eq_u32 s9, 0
  s_cbranch_scc1 L_comm
  s_mov_b32 exec_lo, s9
  s_mov_b32 exec_hi, 0
  ds_read_b128 v[16:19], v5 offset:6144
  ds_read_b128 v[20:23], v5 offset:6400
  ds_read_b128 v[24:27], v5 offset:6656
  ds_read_b128 v[28:31], v5 offset:6912
  ds_read_b128 v[32:35], v5 offset:7168
  ds_read_b128 v[36:39], v5 offset:7424
  ds_read_b128 v[40:43], v5 offset:7680
  ds_read_b128 v[44:47], v5 offset:7936
  s_waitcnt lgkmcnt(6)
  v_pk_add_f32 v[16:17], v[16:17], v[20:21]
  v_pk_add_f32 v[18:19], v[18:19], v[22:23]
  s_waitcnt lgkmcnt(4)
  v_pk_add_f32 v[24:25], v[24:25], v[28:29]
  v_pk_add_f32 v[26:27], v[26:27], v[30:31]
  v_pk_add_f32 v[16:17], v[16:17], v[24:25]
  v_pk_add_f32 v[18:19], v[18:19], v[26:27]
  s_waitcnt lgkmcnt(2)
  v_pk_add_f32 v[32:33], v[32:33], v[36:37]
  v_pk_add_f32 v[34:35], v[34:35], v[38:39]
  v_pk_add_f32 v[16:17], v[16:17], v[32:33]
  v_pk_add_f32 v[18:19], v[18:19], v[34:35]
  s_waitcnt lgkmcnt(0)
  v_pk_add_f32 v[40:41], v[40:41], v[44:45]
  v_pk_add_f32 v[42:43], v[42:43], v[46:47]
  v_pk_add_f32 v[16:17], v[16:17], v[40:41]
  v_pk_add_f32 v[18:19], v[18:19], v[42:43]
  v_add_u32 v16, 0x800, v16
  v_add_u32 v17, 0x800, v17
  v_add_u32 v18, 0x800, v18
  v_add_u32 v19, 0x800, v19
  v_and_or_b32 v16, v16, v4, s68
  v_and_or_b32 v17, v17, v4, s68
  v_and_or_b32 v18, v18, v4, s68
  v_and_or_b32 v19, v19, v4, s68
  buffer_store_dwordx4 v[16:19], v6, s[60:63], s4 offen sc1
  s_mov_b64 exec, -1
  s_branch L_comm
L_PLN:
  s_mov_b32 s62, 0x200000
  s_mov_b32 s63, 0x20000
  v_mov_b32 v4, 0xfffff000
  s_mov_b32 s70, 300000
  s_getpc_b64 s[22:23]
L_pt4:
  s_and_b32 s24, s73, 0xfc
  s_add_u32 s24, s24, L_tiles-L_pt4
  s_load_dword s71, s[22:23], s24
  s_load_dword s69, s[60:61], 0
  s_waitcnt vmcnt(1)
  v_lshlrev_b32 v32, 16, v16
  v_and_b32 v33, 0xffff0000, v16
  v_lshlrev_b32 v34, 16, v17
  v_and_b32 v35, 0xffff0000, v17
  v_lshlrev_b32 v36, 16, v18
  v_and_b32 v37, 0xffff0000, v18
  v_lshlrev_b32 v38, 16, v19
  v_and_b32 v39, 0xffff0000, v19
  v_lshlrev_b32 v40, 16, v20
  v_and_b32 v41, 0xffff0000, v20
  v_lshlrev_b32 v42, 16, v21
  v_and_b32 v43, 0xffff0000, v21
  v_lshlrev_b32 v44, 16, v22
  v_and_b32 v45, 0xffff0000, v22
  v_lshlrev_b32 v46, 16, v23
  v_and_b32 v47, 0xffff0000, v23
  v_pk_add_f32 v[8:9], v[32:33], v[34:35]
  v_pk_add_f32 v[8:9], v[8:9], v[36:37]
  v_pk_add_f32 v[8:9], v[8:9], v[38:39]
  v_pk_add_f32 v[8:9], v[8:9], v[40:41]
  v_pk_add_f32 v[8:9], v[8:9], v[42:43]
  v_pk_add_f32 v[8:9], v[8:9], v[44:45]
  v_pk_add_f32 v[8:9], v[8:9], v[46:47]
  v_add_f32 v7, v8, v9
  s_nop 1
  v_add_f32_dpp v7, v7, v7 row_shr:1 row_mask:0xf bank_mask:0xf bound_ctrl:0
  s_nop 1
  v_add_f32_dpp v7, v7, v7 row_shr:2 row_mask:0xf bank_mask:0xf bound_ctrl:0
  s_nop 1
  v_add_f32_dpp v7, v7, v7 row_shr:4 row_mask:0xf bank_mask:0xf bound_ctrl:0
  s_nop 1
  v_add_f32_dpp v7, v7, v7 row_shr:8 row_mask:0xf bank_mask:0xf bound_ctrl:0
  s_nop 1
  v_add_f32_dpp v7, v7, v7 row_bcast:15 row_mask:0xa bank_mask:0xf
  s_nop 1
  v_add_f32_dpp v7, v7, v7 row_bcast:31 row_mask:0xc bank_mask:0xf
  s_nop 0
  v_readlane_b32 s8, v7, 63
  v_mov_b32 v10, 0xba800000
  s_nop 0
  v_mul_f32 v10, s8, v10
  v_mov_b32 v11, v10
  v_pk_add_f32 v[32:33], v[32:33], v[10:11]
  v_pk_add_f32 v[34:35], v[34:35], v[10:11]
  v_pk_add_f32 v[36:37], v[36:37], v[10:11]
  v_pk_add_f32 v[38:39], v[38:39], v[10:11]
  v_pk_add_f32 v[40:41], v[40:41], v[10:11]
  v_pk_add_f32 v[42:43], v[42:43], v[10:11]
  v_pk_add_f32 v[44:45], v[44:45], v[10:11]
  v_pk_add_f32 v[46:47], v[46:47], v[10:11]
  v_pk_mul_f32 v[8:9], v[32:33], v[32:33]
  v_pk_fma_f32 v[8:9], v[34:35], v[34:35], v[8:9]
  v_pk_fma_f32 v[8:9], v[36:37], v[36:37], v[8:9]
  v_pk_fma_f32 v[8:9], v[38:39], v[38:39], v[8:9]
  v_pk_fma_f32 v[8:9], v[40:41], v[40:41], v[8:9]
  v_pk_fma_f32 v[8:9], v[42:43], v[42:43], v[8:9]
  v_pk_fma_f32 v[8:9], v[44:45], v[44:45], v[8:9]
  v_pk_fma_f32 v[8:9], v[46:47], v[46:47], v[8:9]
  v_add_f32 v7, v8, v9
  s_nop 1
  v_add_f32_dpp v7, v7, v7 row_shr:1 row_mask:0xf bank_mask:0xf bound_ctrl:0
  s_nop 1
  v_add_f32_dpp v7, v7, v7 row_shr:2 row_mask:0xf bank_mask:0xf bound_ctrl:0
  s_nop 1
  v_add_f32_dpp v7, v7, v7 row_shr:4 row_mask:0xf bank_mask:0xf bound_ctrl:0
  s_nop 1
  v_add_f32_dpp v7, v7, v7 row_shr:8 row_mask:0xf bank_mask:0xf bound_ctrl:0
  s_nop 1
  v_add_f32_dpp v7, v7, v7 row_bcast:15 row_mask:0xa bank_mask:0xf
  s_nop 1
  v_add_f32_dpp v7, v7, v7 row_bcast:31 row_mask:0xc bank_mask:0xf
  s_nop 0
  v_readlane_b32 s8, v7, 63
  v_mov_b32 v15, 0x3a800000
  v_cvt_pk_bf16_f32 v10, 0, v10
  v_mul_f32 v15, s8, v15
  v_cvt_pk_bf16_f32 v15, 0, v15
  v_add_f32 v15, 0x3727c5ac, v15
  v_cvt_pk_bf16_f32 v15, 0, v15
  v_sqrt_f32 v15, v15
  s_waitcnt vmcnt(0)
  v_cvt_pk_bf16_f32 v15, 0, v15
  v_rcp_f32 v15, v15
  v_lshlrev_b32 v48, 16, v24
  v_and_b32 v49, 0xffff0000, v24
  v_lshlrev_b32 v50, 16, v25
  v_and_b32 v51, 0xffff0000, v25
  v_lshlrev_b32 v52, 16, v26
  v_and_b32 v53, 0xffff0000, v26
  v_lshlrev_b32 v54, 16, v27
  v_and_b32 v55, 0xffff0000, v27
  v_add_f32 v48, v48, v10
  v_add_f32 v49, v49, v10
  v_add_f32 v50, v50, v10
  v_add_f32 v51, v51, v10
  v_add_f32 v52, v52, v10
  v_add_f32 v53, v53, v10
  v_add_f32 v54, v54, v10
  v_add_f32 v55, v55, v10
  v_cvt_pk_bf16_f32 v48, 0, v48
  v_cvt_pk_bf16_f32 v49, 0, v49
  v_cvt_pk_bf16_f32 v50, 0, v50
  v_cvt_pk_bf16_f32 v51, 0, v51
  v_cvt_pk_bf16_f32 v52, 0, v52
  v_cvt_pk_bf16_f32 v53, 0, v53
  v_cvt_pk_bf16_f32 v54, 0, v54
  v_cvt_pk_bf16_f32 v55, 0, v55
  v_mul_f32 v48, v48, v15
  v_mul_f32 v49, v49, v15
  v_mul_f32 v50, v50, v15
  v_mul_f32 v51, v51, v15
  v_mul_f32 v52, v52, v15
  v_mul_f32 v53, v53, v15
  v_mul_f32 v54, v54, v15
  v_mul_f32 v55, v55, v15
  v_cvt_pk_bf16_f32 v48, v48, v48
  v_cvt_pk_bf16_f32 v49, v49, v49
  v_cvt_pk_bf16_f32 v50, v50, v50
  v_cvt_pk_bf16_f32 v51, v51, v51
  v_cvt_pk_bf16_f32 v52, v52, v52
  v_cvt_pk_bf16_f32 v53, v53, v53
  v_cvt_pk_bf16_f32 v54, v54, v54
  v_cvt_pk_bf16_f32 v55, v55, v55
  ds_write_b128 v5, v[48:51] offset:0
  ds_write_b128 v5, v[52:55] offset:16
  s_waitcnt lgkmcnt(0)
  s_add_u32 s69, s69, 1
  s_and_b32 s68, s69, 0xfff
  s_and_b32 s27, s69, 0xff
  s_barrier
  s_setprio 2
  s_and_b32 s24, s73, 3
  s_lshl_b32 s24, s24, 3
  s_lshr_b32 s71, s71, s24
  s_and_b32 s71, s71, 0xff
  s_and_b32 s24, s3, 2
  s_lshl_b32 s24, s24, 1
  s_add_u32 s71, s71, s24
  s_barrier
  s_barrier
  s_branch L_comm
L_A2:
  s_load_dword s69, s[60:61], 0
  s_load_dwordx2 s[56:57], s[0:1], 16
  s_load_dwordx2 s[48:49], s[0:1], 64
  s_mov_b32 s58, 0x2000000
  s_mov_b32 s59, 0x20000
  s_mov_b32 s62, 0x200000
  s_mov_b32 s63, 0x20000
  v_mov_b32 v4, 0xfffff000
  s_mov_b32 s70, 300000
  s_and_b32 s71, s3, 2
  s_add_u32 s71, s71, s77
  s_lshl_b32 s71, s71, 1
  s_add_u32 s71, s71, 192
  v_add_u32 v15, 0, v5
  v_lshlrev_b32 v15, 1, v15
  v_xor_b32 v15, v15, v6
  v_lshl_add_u32 v228, v15, 4, v7
  v_add_u32 v15, 4, v5
  v_lshlrev_b32 v15, 1, v15
  v_xor_b32 v15, v15, v6
  v_lshl_add_u32 v229, v15, 4, v7
  v_mov_b32 v15, 0xff800000
  v_and_b32 v16, 7, v1
  v_lshlrev_b32 v16, 2, v16
  ds_write_b32 v16, v15 offset:2304
  v_lshlrev_b32 v14, 3, v1
  v_lshlrev_b32 v22, 3, v16
  s_lshl_b32 s13, s3, 2
  v_add_u32 v23, s13, v22
  v_lshlrev_b32 v7, 8, v6
  v_add_u32 v7, s8, v7
  v_add_u32 v15, 0, v5
  v_xor_b32 v15, v15, v6
  v_lshl_add_u32 v8, v15, 4, v7
  v_add_u32 v15, 4, v5
  v_xor_b32 v15, v15, v6
  v_lshl_add_u32 v9, v15, 4, v7
  v_add_u32 v15, 8, v5
  v_xor_b32 v15, v15, v6
  v_lshl_add_u32 v10, v15, 4, v7
  v_add_u32 v15, 12, v5
  v_xor_b32 v15, v15, v6
  v_lshl_add_u32 v11, v15, 4, v7
  v_lshrrev_b32 v15, 2, v1
  v_lshlrev_b32 v12, 8, v15
  v_and_b32 v15, 7, v15
  v_xor_b32 v15, s3, v15
  v_lshl_add_u32 v12, v15, 5, v12
  v_and_b32 v15, 3, v1
  v_lshl_add_u32 v12, v15, 3, v12
  v_add_u32 v12, 81920, v12
  v_and_b32 v15, 7, v1
  v_mul_u32_u24 v13, 288, v15
  v_lshl_add_u32 v13, v5, 4, v13
  s_lshl_b32 s10, s4, 12
  s_lshl_b32 s11, s3, 9
  s_add_u32 s10, s10, s11
  s_add_u32 s10, s10, 786432
  s_add_u32 s11, s10, 16384
  s_add_u32 s12, s10, 32768
  s_mul_i32 s13, s3, 288
  v_lshlrev_b32 v17, 2, v1
  v_add_u32 v17, s13, v17
  v_lshl_add_u32 v18, v5, 7, v3
  s_lshl_b32 s13, s3, 9
  v_and_b32 v19, 8, v1
  v_add3_u32 v19, v19, v18, s13
  v_lshlrev_b32 v20, 13, v15
  v_lshl_add_u32 v20, v5, 4, v20
  s_lshl_b32 s14, s4, 16
  s_lshl_b32 s13, s5, 9
  s_add_u32 s14, s14, s13
  s_lshl_b32 s13, s3, 6
  s_add_u32 s14, s14, s13
  s_add_u32 s14, s14, 262144
  s_lshl_b32 s15, s4, 7
  s_add_u32 s15, s15, s5
  s_lshl_b32 s15, s15, 7
  s_add_u32 s15, s15, 196608
  v_lshlrev_b32 v231, 11, v15
  v_lshl_add_u32 v231, v5, 4, v231
  v_and_b32 v15, 8, v1
  v_lshl_add_u32 v231, v15, 3, v231
  v_cmp_ne_u32 s[18:19], 0, v15
  v_lshl_add_u32 v230, v2, 11, v3
  v_mov_b32 v80, 0
  v_mov_b32 v81, 0
  v_mov_b32 v82, 0
  v_mov_b32 v83, 0
  v_mov_b32 v84, 0
  v_mov_b32 v85, 0
  v_mov_b32 v86, 0
  v_mov_b32 v87, 0
  v_mov_b32 v24, 0
  v_mov_b32 v25, 0
  v_mov_b32 v26, 0
  v_mov_b32 v27, 0
  v_mov_b32 v28, 0
  v_mov_b32 v29, 0
  v_mov_b32 v30, 0
  v_mov_b32 v31, 0
  v_mov_b32 v88, 0x3f803f80
  v_mov_b32 v89, 0x3f803f80
  v_mov_b32 v90, 0x3f803f80
  v_mov_b32 v91, 0x3f803f80
  s_mov_b32 s16, 0x3db504f3
  s_mov_b32 s17, 0x3fb8aa3b
  s_waitcnt lgkmcnt(0)
  s_add_u32 s69, s69, 1
  s_and_b32 s68, s69, 0xfff
  s_and_b32 s27, s69, 0xff
  s_and_b32 s76, s2, 7
  s_lshl_b32 s76, s76, 8
  s_and_b32 s77, s3, 1
  s_lshl_b32 s77, s77, 7
  s_add_u32 s76, s76, s77
  s_bfe_u32 s77, s71, 0x40002
  s_mul_i32 s72, s77, 131072
  s_add_u32 s72, s72, 5242880
  s_add_u32 s72, s72, s76
  s_mov_b32 s44, s48
  s_mov_b32 s45, s49
  s_mov_b32 s46, 0x700000
  s_mov_b32 s47, 0x20000
  s_cmp_lg_u32 s3, 6
  s_cbranch_scc1 L_Anx
  s_getreg_b32 s22, hwreg(HW_REG_XCC_ID, 0, 4)
  s_lshl_b32 s22, s22, 12
  s_or_b32 s22, s22, s68
  s_and_b32 s23, s2, 7
  s_lshl_b32 s23, s23, 3
  s_lshr_b32 s24, s2, 5
  s_add_u32 s23, s23, s24
  s_lshl_b32 s23, s23, 7
  s_add_u32 s23, s23, 131072
  v_mov_b32 v144, s22
  v_mov_b32 v145, s22
  v_mov_b32 v146, s22
  v_mov_b32 v147, s22
  s_mov_b64 exec, 0xff
  buffer_store_dwordx4 v[144:147], v3, s[60:63], s23 offen sc1
  s_mov_b64 exec, -1
L_Anx:
  s_waitcnt vmcnt(7)
  s_add_u32 m0, s8, 65536
  s_nop 0
  buffer_load_dwordx4 v228, s[56:59], s6 offen offset:0 nt lds
  s_waitcnt vmcnt(7)
  buffer_load_dwordx4 v229, s[56:59], s6 offen offset:1024 nt lds
  s_waitcnt vmcnt(7)
  buffer_load_dwordx4 v228, s[56:59], s6 offen offset:2048 nt lds
  s_waitcnt vmcnt(7)
  buffer_load_dwordx4 v229, s[56:59], s6 offen offset:3072 nt lds
  s_waitcnt vmcnt(7)
  s_add_u32 m0, s8, 69632
  s_nop 0
  buffer_load_dwordx4 v228, s[56:59], s9 offen offset:0 nt lds
  s_waitcnt vmcnt(7)
  buffer_load_dwordx4 v229, s[56:59], s9 offen offset:1024 nt lds
  s_waitcnt vmcnt(7)
  buffer_load_dwordx4 v228, s[56:59], s9 offen offset:2048 nt lds
  s_waitcnt vmcnt(7)
  buffer_load_dwordx4 v229, s[56:59], s9 offen offset:3072 nt lds
  s_waitcnt vmcnt(5)
  s_barrier
  buffer_load_dwordx2 v[192:193], v14, s[60:63], s10 offen sc1
  buffer_load_dwordx2 v[194:195], v14, s[60:63], s11 offen sc1
  buffer_load_dwordx2 v[196:197], v14, s[60:63], s12 offen sc1
  s_cmp_lg_u32 s3, 6
  s_cbranch_scc1 L_Anx2
  s_and_b32 s22, s2, 7
  s_lshl_b32 s22, s22, 10
  s_add_u32 s22, s22, 131072
  v_lshlrev_b32 v152, 3, v3
  buffer_load_dwordx4 v[148:151], v152, s[60:63], s22 offen sc1
L_Anx2:
  ds_read_b128 v[32:35], v8 offset:0
  ds_read_b128 v[36:39], v9 offset:0
  ds_read_b128 v[40:43], v10 offset:0
  ds_read_b128 v[44:47], v11 offset:0
  ds_read_b128 v[48:51], v8 offset:4096
  ds_read_b128 v[52:55], v9 offset:4096
  ds_read_b128 v[56:59], v10 offset:4096
  ds_read_b128 v[60:63], v11 offset:4096
  s_waitcnt vmcnt(0)
  v_xor_b32 v64, s27, v192
  v_xor_b32 v65, s27, v193
  v_xor_b32 v66, s27, v194
  v_xor_b32 v67, s27, v195
  v_xor_b32 v68, s27, v196
  v_xor_b32 v69, s27, v197
  v_or3_b32 v15, v64, v65, v66
  v_or3_b32 v15, v15, v67, v68
  v_or_b32 v15, v15, v69
  v_and_b32 v15, 0xff, v15
  v_cmp_ne_u32 vcc, 0, v15
  s_cbranch_vccz L_Aq_ok
  buffer_load_dwordx2 v[232:233], v14, s[60:63], s10 offen sc1
  buffer_load_dwordx2 v[234:235], v14, s[60:63], s11 offen sc1
  buffer_load_dwordx2 v[236:237], v14, s[60:63], s12 offen sc1
  s_sleep 1
  buffer_load_dwordx2 v[238:239], v14, s[60:63], s10 offen sc1
  buffer_load_dwordx2 v[240:241], v14, s[60:63], s11 offen sc1
  buffer_load_dwordx2 v[242:243], v14, s[60:63], s12 offen sc1
  s_sleep 1
  buffer_load_dwordx2 v[244:245], v14, s[60:63], s10 offen sc1
  buffer_load_dwordx2 v[246:247], v14, s[60:63], s11 offen sc1
  buffer_load_dwordx2 v[248:249], v14, s[60:63], s12 offen sc1
L_Aq:
  s_waitcnt vmcnt(6)
  v_xor_b32 v64, s27, v232
  v_xor_b32 v65, s27, v233
  v_xor_b32 v66, s27, v234
  v_xor_b32 v67, s27, v235
  v_xor_b32 v68, s27, v236
  v_xor_b32 v69, s27, v237
  v_or3_b32 v15, v64, v65, v66
  v_or3_b32 v15, v15, v67, v68
  v_or_b32 v15, v15, v69
  v_and_b32 v15, 0xff, v15
  v_cmp_ne_u32 vcc, 0, v15
  s_cbranch_vccz L_Aq_ok
  buffer_load_dwordx2 v[232:233], v14, s[60:63], s10 offen sc1
  buffer_load_dwordx2 v[234:235], v14, s[60:63], s11 offen sc1
  buffer_load_dwordx2 v[236:237], v14, s[60:63], s12 offen sc1
  s_waitcnt vmcnt(6)
  v_xor_b32 v64, s27, v238
  v_xor_b32 v65, s27, v239
  v_xor_b32 v66, s27, v240
  v_xor_b32 v67, s27, v241
  v_xor_b32 v68, s27, v242
  v_xor_b32 v69, s27, v243
  v_or3_b32 v15, v64, v65, v66
  v_or3_b32 v15, v15, v67, v68
  v_or_b32 v15, v15, v69
  v_and_b32 v15, 0xff, v15
  v_cmp_ne_u32 vcc, 0, v15
  s_cbranch_vccz L_Aq_ok
  buffer_load_dwordx2 v[238:239], v14, s[60:63], s10 offen sc1
  buffer_load_dwordx2 v[240:241], v14, s[60:63], s11 offen sc1
  buffer_load_dwordx2 v[242:243], v14, s[60:63], s12 offen sc1
  s_waitcnt vmcnt(6)
  v_xor_b32 v64, s27, v244
  v_xor_b32 v65, s27, v245
  v_xor_b32 v66, s27, v246
  v_xor_b32 v67, s27, v247
  v_xor_b32 v68, s27, v248
  v_xor_b32 v69, s27, v249
  v_or3_b32 v15, v64, v65, v66
  v_or3_b32 v15, v15, v67, v68
  v_or_b32 v15, v15, v69
  v_and_b32 v15, 0xff, v15
  v_cmp_ne_u32 vcc, 0, v15
  s_cbranch_vccz L_Aq_ok
  buffer_load_dwordx2 v[244:245], v14, s[60:63], s10 offen sc1
  buffer_load_dwordx2 v[246:247], v14, s[60:63], s11 offen sc1
  buffer_load_dwordx2 v[248:249], v14, s[60:63], s12 offen sc1
  s_cmp_eq_u32 s70, 0
  s_cbranch_scc1 L_Aq_ok
  s_sub_u32 s70, s70, 1
  s_branch L_Aq
L_Aq_ok:
  v_pk_add_f32 v[64:65], v[64:65], v[66:67]
  v_pk_add_f32 v[64:65], v[64:65], v[68:69]
  v_cvt_pk_bf16_f32 v15, v64, v65
  ds_write_b32 v17, v15 offset:0
  s_waitcnt lgkmcnt(0)
  s_barrier
  ds_read_b128 v[64:67], v13 offset:0
  ds_read_b128 v[68:71], v13 offset:64
  ds_read_b128 v[72:75], v13 offset:128
  ds_read_b128 v[76:79], v13 offset:192
  s_waitcnt lgkmcnt(3)
  v_mfma_f32_16x16x32_bf16 v[80:83], v[32:35], v[64:67], v[80:83]
  v_mfma_f32_16x16x32_bf16 v[84:87], v[48:51], v[64:67], v[84:87]
  s_waitcnt lgkmcnt(2)
  v_mfma_f32_16x16x32_bf16 v[80:83], v[36:39], v[68:71], v[80:83]
  v_mfma_f32_16x16x32_bf16 v[84:87], v[52:55], v[68:71], v[84:87]
  s_waitcnt lgkmcnt(1)
  v_mfma_f32_16x16x32_bf16 v[80:83], v[40:43], v[72:75], v[80:83]
  v_mfma_f32_16x16x32_bf16 v[84:87], v[56:59], v[72:75], v[84:87]
  s_waitcnt lgkmcnt(0)
  v_mfma_f32_16x16x32_bf16 v[80:83], v[44:47], v[76:79], v[80:83]
  v_mfma_f32_16x16x32_bf16 v[84:87], v[60:63], v[76:79], v[84:87]
  ds_read_b64_tr_b16 v[160:161], v12 offset:0
  ds_read_b64_tr_b16 v[162:163], v12 offset:4096
  ds_read_b64_tr_b16 v[164:165], v12 offset:8192
  ds_read_b64_tr_b16 v[166:167], v12 offset:12288
  ds_read_b64_tr_b16 v[168:169], v12 offset:16384
  ds_read_b64_tr_b16 v[170:171], v12 offset:20480
  ds_read_b64_tr_b16 v[172:173], v12 offset:24576
  ds_read_b64_tr_b16 v[174:175], v12 offset:28672
  v_cndmask_b32 v80, v80, v84, s[18:19]
  v_cndmask_b32 v81, v81, v85, s[18:19]
  v_cndmask_b32 v82, v82, v86, s[18:19]
  v_cndmask_b32 v83, v83, v87, s[18:19]
  v_cvt_pk_bf16_f32 v80, 0, v80
  v_cvt_pk_bf16_f32 v81, 0, v81
  v_cvt_pk_bf16_f32 v82, 0, v82
  v_cvt_pk_bf16_f32 v83, 0, v83
  v_mul_f32 v80, s16, v80
  v_mul_f32 v81, s16, v81
  v_mul_f32 v82, s16, v82
  v_mul_f32 v83, s16, v83
  v_cvt_pk_bf16_f32 v80, 0, v80
  v_cvt_pk_bf16_f32 v81, 0, v81
  v_cvt_pk_bf16_f32 v82, 0, v82
  v_cvt_pk_bf16_f32 v83, 0, v83
  v_max3_f32 v15, v80, v81, v82
  v_max_f32 v15, v15, v83
  ds_max_f32 v16, v15 offset:2304
  s_waitcnt lgkmcnt(0)
  s_barrier
  ds_read_b32 v21, v16 offset:2304
  ds_read_b64_tr_b16 v[176:177], v12 offset:32768
  ds_read_b64_tr_b16 v[178:179], v12 offset:36864
  ds_read_b64_tr_b16 v[180:181], v12 offset:40960
  ds_read_b64_tr_b16 v[182:183], v12 offset:45056
  ds_read_b64_tr_b16 v[184:185], v12 offset:49152
  ds_read_b64_tr_b16 v[186:187], v12 offset:53248
  ds_read_b64_tr_b16 v[188:189], v12 offset:57344
  ds_read_b64_tr_b16 v[190:191], v12 offset:61440
  v_mul_f32 v80, s17, v80
  v_mul_f32 v81, s17, v81
  v_mul_f32 v82, s17, v82
  v_mul_f32 v83, s17, v83
  s_waitcnt lgkmcnt(8)
  v_fma_f32 v80, -v21, s17, v80
  v_fma_f32 v81, -v21, s17, v81
  v_fma_f32 v82, -v21, s17, v82
  v_fma_f32 v83, -v21, s17, v83
  v_exp_f32 v80, v80
  v_exp_f32 v81, v81
  v_exp_f32 v82, v82
  v_exp_f32 v83, v83
  s_nop 0
  v_cvt_pk_bf16_f32 v92, v80, v81
  v_cvt_pk_bf16_f32 v93, v82, v83
  ds_write_b64 v19, v[92:93] offset:4096
  s_waitcnt lgkmcnt(0)
  s_barrier
  ds_read_b128 v[192:195], v18 offset:4096
  ds_read_b128 v[196:199], v18 offset:4608
  ds_read_b128 v[200:203], v18 offset:5120
  ds_read_b128 v[204:207], v18 offset:5632
  ds_read_b128 v[208:211], v18 offset:6144
  ds_read_b128 v[212:215], v18 offset:6656
  ds_read_b128 v[216:219], v18 offset:7168
  ds_read_b128 v[220:223], v18 offset:7680
  s_cmp_lg_u32 s3, 7
  s_cbranch_scc1 L_Anol
  s_waitcnt lgkmcnt(7)
  v_mfma_f32_16x16x32_bf16 v[28:31], v[88:91], v[192:195], v[28:31]
  s_waitcnt lgkmcnt(6)
  v_mfma_f32_16x16x32_bf16 v[28:31], v[88:91], v[196:199], v[28:31]
  s_waitcnt lgkmcnt(5)
  v_mfma_f32_16x16x32_bf16 v[28:31], v[88:91], v[200:203], v[28:31]
  s_waitcnt lgkmcnt(4)
  v_mfma_f32_16x16x32_bf16 v[28:31], v[88:91], v[204:207], v[28:31]
  s_waitcnt lgkmcnt(3)
  v_mfma_f32_16x16x32_bf16 v[28:31], v[88:91], v[208:211], v[28:31]
  s_waitcnt lgkmcnt(2)
  v_mfma_f32_16x16x32_bf16 v[28:31], v[88:91], v[212:215], v[28:31]
  s_waitcnt lgkmcnt(1)
  v_mfma_f32_16x16x32_bf16 v[28:31], v[88:91], v[216:219], v[28:31]
  s_waitcnt lgkmcnt(0)
  v_mfma_f32_16x16x32_bf16 v[28:31], v[88:91], v[220:223], v[28:31]
  v_mfma_f32_16x16x32_bf16 v[24:27], v[160:163], v[192:195], v[24:27]
  v_mfma_f32_16x16x32_bf16 v[24:27], v[164:167], v[196:199], v[24:27]
  v_mfma_f32_16x16x32_bf16 v[24:27], v[168:171], v[200:203], v[24:27]
  v_mfma_f32_16x16x32_bf16 v[24:27], v[172:175], v[204:207], v[24:27]
  s_nop 3
  v_mov_b32 v28, v21
  v_mov_b32 v30, v21
  v_add_u32 v28, 0x800, v28
  v_add_u32 v29, 0x800, v29
  v_add_u32 v30, 0x800, v30
  v_add_u32 v31, 0x800, v31
  v_and_or_b32 v28, v28, v4, s68
  v_and_or_b32 v29, v29, v4, s68
  v_and_or_b32 v30, v30, v4, s68
  v_and_or_b32 v31, v31, v4, s68
  buffer_store_dwordx4 v[28:31], v231, s[60:63], s15 offen sc1
  s_branch L_Apv4
L_Anol:
  s_waitcnt lgkmcnt(7)
  v_mfma_f32_16x16x32_bf16 v[24:27], v[160:163], v[192:195], v[24:27]
  s_waitcnt lgkmcnt(6)
  v_mfma_f32_16x16x32_bf16 v[24:27], v[164:167], v[196:199], v[24:27]
  s_waitcnt lgkmcnt(5)
  v_mfma_f32_16x16x32_bf16 v[24:27], v[168:171], v[200:203], v[24:27]
  s_waitcnt lgkmcnt(4)
  v_mfma_f32_16x16x32_bf16 v[24:27], v[172:175], v[204:207], v[24:27]
L_Apv4:
  s_waitcnt lgkmcnt(3)
  v_mfma_f32_16x16x32_bf16 v[24:27], v[176:179], v[208:211], v[24:27]
  s_waitcnt lgkmcnt(2)
  v_mfma_f32_16x16x32_bf16 v[24:27], v[180:183], v[212:215], v[24:27]
  s_waitcnt lgkmcnt(1)
  v_mfma_f32_16x16x32_bf16 v[24:27], v[184:187], v[216:219], v[24:27]
  s_waitcnt lgkmcnt(0)
  v_mfma_f32_16x16x32_bf16 v[24:27], v[188:191], v[220:223], v[24:27]
  s_nop 7
  v_add_u32 v24, 0x800, v24
  v_add_u32 v25, 0x800, v25
  v_add_u32 v26, 0x800, v26
  v_add_u32 v27, 0x800, v27
  v_and_or_b32 v24, v24, v4, s68
  v_and_or_b32 v25, v25, v4, s68
  v_and_or_b32 v26, v26, v4, s68
  v_and_or_b32 v27, v27, v4, s68
  s_mov_b32 exec_lo, 0xff00ff
  s_mov_b32 exec_hi, 0xff00ff
  buffer_store_dwordx4 v[24:27], v20, s[60:63], s14 offen sc1
  s_mov_b64 exec, -1
L_Anoml:
  s_cmp_lg_u32 s3, 6
  s_cbranch_scc1 L_Anx3
  s_getreg_b32 s22, hwreg(HW_REG_XCC_ID, 0, 4)
  s_lshl_b32 s22, s22, 12
  s_or_b32 s22, s22, s68
  v_xor_b32 v148, s22, v148
  v_xor_b32 v149, s22, v149
  v_xor_b32 v150, s22, v150
  v_xor_b32 v151, s22, v151
  v_or3_b32 v148, v148, v149, v150
  v_or_b32 v148, v148, v151
  v_cmp_ne_u32 vcc, 0, v148
  s_cmp_eq_u64 vcc, 0
  s_cselect_b32 s22, 1, 0
  v_mov_b32 v148, s22
  v_mov_b32 v152, 13856
  ds_write_b32 v152, v148
  s_waitcnt lgkmcnt(0)
L_Anx3:
  s_barrier
  s_cmp_ge_u32 s3, 4
  s_cbranch_scc1 L_hpath
  buffer_load_dwordx4 v[96:99], v230, s[44:47], s72 offen nt
  s_add_u32 s72, s72, 16384
  buffer_load_dwordx4 v[100:103], v230, s[44:47], s72 offen nt
  s_add_u32 s72, s72, 16384
  buffer_load_dwordx4 v[104:107], v230, s[44:47], s72 offen nt
  s_add_u32 s72, s72, 16384
  buffer_load_dwordx4 v[108:111], v230, s[44:47], s72 offen nt
  s_add_u32 s72, s72, 16384
  buffer_load_dwordx4 v[112:115], v230, s[44:47], s72 offen nt
  s_add_u32 s72, s72, 16384
  buffer_load_dwordx4 v[116:119], v230, s[44:47], s72 offen nt
  s_add_u32 s72, s72, 16384
  buffer_load_dwordx4 v[120:123], v230, s[44:47], s72 offen nt
  s_add_u32 s72, s72, 16384
  buffer_load_dwordx4 v[124:127], v230, s[44:47], s72 offen nt
  s_add_u32 s72, s72, 16384
  v_and_b32 v5, 1, v1
  v_lshlrev_b32 v5, 4, v5
  v_mov_b32 v6, 0xffff
  v_lshlrev_b32 v6, v5, v6
  v_bfe_u32 v5, v1, 1, 2
  v_cmp_eq_u32 vcc, 0, v5
  s_nop 1
  v_cndmask_b32 v8, 0, v6, vcc
  v_cmp_eq_u32 vcc, 1, v5
  s_nop 1
  v_cndmask_b32 v9, 0, v6, vcc
  v_cmp_eq_u32 vcc, 2, v5
  s_nop 1
  v_cndmask_b32 v10, 0, v6, vcc
  v_cmp_eq_u32 vcc, 3, v5
  s_nop 1
  v_cndmask_b32 v11, 0, v6, vcc
  v_mul_u32_u24 v5, 80, v2
  s_and_b32 s4, s3, 2
  s_mul_i32 s4, s4, 320
  s_add_u32 s4, s4, 12288
  v_add_u32 v5, s4, v5
  v_lshlrev_b32 v6, 1, v3
  v_and_b32 v13, 16, v1
  v_add_u32 v6, v6, v13
  s_lshl_b32 s4, s71, 10
  s_and_b32 s5, s2, 7
  s_lshl_b32 s5, s5, 9
  s_add_u32 s4, s4, s5
  s_and_b32 s5, s3, 1
  s_lshl_b32 s5, s5, 8
  s_add_u32 s4, s4, s5
  s_add_u32 s4, s4, 524288
  v_mov_b32 v13, 13856
  ds_read_b32 v13, v13
  s_waitcnt lgkmcnt(0)
  v_readfirstlane_b32 s5, v13
  s_barrier
  ds_read_b128 v[200:203], v5 offset:0
  ds_read_b128 v[204:207], v5 offset:16
  s_waitcnt lgkmcnt(1)
  v_and_b32 v32, v200, v8
  v_and_b32 v33, v200, v9
  v_and_b32 v34, v200, v10
  v_and_b32 v35, v200, v11
  v_and_b32 v36, v201, v8
  v_and_b32 v37, v201, v9
  v_and_b32 v38, v201, v10
  v_and_b32 v39, v201, v11
  s_waitcnt vmcnt(7)
  v_mfma_f32_16x16x32_bf16 v[16:19], v[32:35], v[96:99], 0
  v_and_b32 v40, v202, v8
  v_and_b32 v41, v202, v9
  v_and_b32 v42, v202, v10
  v_and_b32 v43, v202, v11
  s_waitcnt vmcnt(6)
  v_mfma_f32_16x16x32_bf16 v[16:19], v[36:39], v[100:103], v[16:19]
  v_and_b32 v44, v203, v8
  v_and_b32 v45, v203, v9
  v_and_b32 v46, v203, v10
  v_and_b32 v47, v203, v11
  s_waitcnt vmcnt(5)
  v_mfma_f32_16x16x32_bf16 v[16:19], v[40:43], v[104:107], v[16:19]
  s_waitcnt lgkmcnt(0)
  v_and_b32 v48, v204, v8
  v_and_b32 v49, v204, v9
  v_and_b32 v50, v204, v10
  v_and_b32 v51, v204, v11
  s_waitcnt vmcnt(4)
  v_mfma_f32_16x16x32_bf16 v[16:19], v[44:47], v[108:111], v[16:19]
  v_and_b32 v52, v205, v8
  v_and_b32 v53, v205, v9
  v_and_b32 v54, v205, v10
  v_and_b32 v55, v205, v11
  s_waitcnt vmcnt(3)
  v_mfma_f32_16x16x32_bf16 v[16:19], v[48:51], v[112:115], v[16:19]
  v_and_b32 v56, v206, v8
  v_and_b32 v57, v206, v9
  v_and_b32 v58, v206, v10
  v_and_b32 v59, v206, v11
  s_waitcnt vmcnt(2)
  v_mfma_f32_16x16x32_bf16 v[16:19], v[52:55], v[116:119], v[16:19]
  v_and_b32 v60, v207, v8
  v_and_b32 v61, v207, v9
  v_and_b32 v62, v207, v10
  v_and_b32 v63, v207, v11
  s_waitcnt vmcnt(1)
  v_mfma_f32_16x16x32_bf16 v[16:19], v[56:59], v[120:123], v[16:19]
  s_waitcnt vmcnt(0)
  v_mfma_f32_16x16x32_bf16 v[16:19], v[60:63], v[124:127], v[16:19]
  s_nop 7
  v_permlane32_swap_b32 v16, v32
  v_permlane32_swap_b32 v17, v33
  v_permlane32_swap_b32 v18, v34
  v_permlane32_swap_b32 v19, v35
  s_nop 0
  v_add_f32_dpp v16, v32, v16 row_shl:8 row_mask:0xf bank_mask:0xf bound_ctrl:0
  v_add_f32_dpp v17, v33, v17 row_shl:8 row_mask:0xf bank_mask:0xf bound_ctrl:0
  v_add_f32_dpp v18, v34, v18 row_shl:8 row_mask:0xf bank_mask:0xf bound_ctrl:0
  v_add_f32_dpp v19, v35, v19 row_shl:8 row_mask:0xf bank_mask:0xf bound_ctrl:0
  v_add_u32 v16, 0x800, v16
  v_add_u32 v17, 0x800, v17
  v_add_u32 v18, 0x800, v18
  v_add_u32 v19, 0x800, v19
  v_and_or_b32 v16, v16, v4, s68
  v_and_or_b32 v17, v17, v4, s68
  v_and_or_b32 v18, v18, v4, s68
  v_and_or_b32 v19, v19, v4, s68
  s_mov_b64 exec, 0xff00ff
  s_cmp_eq_u32 s5, 1
  s_cbranch_scc0 L_st5
  buffer_store_dwordx4 v[16:19], v6, s[60:63], s4 offen
  s_endpgm
L_st5:
  buffer_store_dwordx4 v[16:19], v6, s[60:63], s4 offen sc1
  s_endpgm
L_comm:
  s_cmp_ge_u32 s71, 128
  s_cbranch_scc1 L_hpath
  s_lshr_b32 s4, s71, 2
  s_and_b32 s5, s3, 1
  s_lshl_b32 s6, s4, 13
  s_lshl_b32 s9, s5, 8
  s_add_u32 s6, s6, s9
  s_add_u32 s6, s6, 262144
  s_lshl_b32 s7, s4, 11
  s_lshl_b32 s8, s5, 6
  s_add_u32 s7, s7, s8
  s_add_u32 s7, s7, 196608
  v_lshrrev_b32 v5, 4, v1
  v_and_b32 v6, 15, v1
  v_lshlrev_b32 v7, 4, v6
  v_lshl_add_u32 v8, v5, 11, v7
  v_add_u32 v7, s9, v7
  v_lshl_add_u32 v9, v5, 2, v6
  v_and_b32 v9, 15, v9
  v_lshlrev_b32 v9, 7, v9
  s_mov_b32 s17, 0x3fb8aa3b
  v_lshl_add_u32 v7, v5, 2, v7
  v_bfe_u32 v10, v7, 2, 3
  v_mul_u32_u24 v10, 80, v10
  v_lshrrev_b32 v7, 5, v7
  v_lshl_add_u32 v7, v7, 2, v10
  s_and_b32 s24, s3, 2
  s_mul_i32 s24, s24, 320
  s_add_u32 s24, s24, 12288
  v_add_u32 v7, s24, v7
  s_barrier
  buffer_load_dwordx4 v[64:67], v9, s[60:63], s7 offen sc1
  buffer_load_dwordx4 v[68:71], v8, s[60:63], s6 offen offset:0 sc1
  buffer_load_dwordx4 v[72:75], v8, s[60:63], s6 offen offset:512 sc1
  buffer_load_dwordx4 v[76:79], v8, s[60:63], s6 offen offset:1024 sc1
  buffer_load_dwordx4 v[80:83], v8, s[60:63], s6 offen offset:1536 sc1
  s_sleep 1
  buffer_load_dwordx4 v[84:87], v9, s[60:63], s7 offen sc1
  buffer_load_dwordx4 v[88:91], v8, s[60:63], s6 offen offset:0 sc1
  buffer_load_dwordx4 v[92:95], v8, s[60:63], s6 offen offset:512 sc1
  buffer_load_dwordx4 v[96:99], v8, s[60:63], s6 offen offset:1024 sc1
  buffer_load_dwordx4 v[100:103], v8, s[60:63], s6 offen offset:1536 sc1
L_op:
  s_waitcnt vmcnt(5)
  v_xor_b32 v32, s68, v64
  v_xor_b32 v33, s68, v65
  v_xor_b32 v34, s68, v66
  v_xor_b32 v35, s68, v67
  v_max_f32_dpp v10, v32, v32 row_ror:1 row_mask:0xf bank_mask:0xf
  v_xor_b32 v36, s68, v68
  v_xor_b32 v37, s68, v69
  v_xor_b32 v38, s68, v70
  v_max_f32_dpp v10, v10, v10 row_ror:2 row_mask:0xf bank_mask:0xf
  v_xor_b32 v39, s68, v71
  v_xor_b32 v40, s68, v72
  v_xor_b32 v41, s68, v73
  v_max_f32_dpp v10, v10, v10 row_ror:4 row_mask:0xf bank_mask:0xf
  v_xor_b32 v42, s68, v74
  v_xor_b32 v43, s68, v75
  v_xor_b32 v44, s68, v76
  v_max_f32_dpp v10, v10, v10 row_ror:8 row_mask:0xf bank_mask:0xf
  v_xor_b32 v45, s68, v77
  v_xor_b32 v46, s68, v78
  v_xor_b32 v47, s68, v79
  v_sub_f32 v10, v32, v10
  v_xor_b32 v48, s68, v80
  v_xor_b32 v49, s68, v81
  v_xor_b32 v50, s68, v82
  v_mul_f32 v10, s17, v10
  v_xor_b32 v51, s68, v83
  v_or3_b32 v15, v32, v33, v34
  v_or3_b32 v15, v15, v35, v36
  v_exp_f32 v10, v10
  v_or3_b32 v15, v15, v37, v38
  v_or3_b32 v15, v15, v39, v40
  v_or3_b32 v15, v15, v41, v42
  v_mul_f32 v11, v10, v33
  v_or3_b32 v15, v15, v43, v44
  v_or3_b32 v15, v15, v45, v46
  v_or3_b32 v15, v15, v47, v48
  v_or3_b32 v15, v15, v49, v50
  v_or_b32 v15, v15, v51
  v_and_b32 v15, 0xfff, v15
  v_cmp_ne_u32 vcc, 0, v15
  s_cbranch_vccz L_op_ok
  buffer_load_dwordx4 v[64:67], v9, s[60:63], s7 offen sc1
  buffer_load_dwordx4 v[68:71], v8, s[60:63], s6 offen offset:0 sc1
  buffer_load_dwordx4 v[72:75], v8, s[60:63], s6 offen offset:512 sc1
  buffer_load_dwordx4 v[76:79], v8, s[60:63], s6 offen offset:1024 sc1
  buffer_load_dwordx4 v[80:83], v8, s[60:63], s6 offen offset:1536 sc1
  s_waitcnt vmcnt(5)
  v_xor_b32 v32, s68, v84
  v_xor_b32 v33, s68, v85
  v_xor_b32 v34, s68, v86
  v_xor_b32 v35, s68, v87
  v_max_f32_dpp v10, v32, v32 row_ror:1 row_mask:0xf bank_mask:0xf
  v_xor_b32 v36, s68, v88
  v_xor_b32 v37, s68, v89
  v_xor_b32 v38, s68, v90
  v_max_f32_dpp v10, v10, v10 row_ror:2 row_mask:0xf bank_mask:0xf
  v_xor_b32 v39, s68, v91
  v_xor_b32 v40, s68, v92
  v_xor_b32 v41, s68, v93
  v_max_f32_dpp v10, v10, v10 row_ror:4 row_mask:0xf bank_mask:0xf
  v_xor_b32 v42, s68, v94
  v_xor_b32 v43, s68, v95
  v_xor_b32 v44, s68, v96
  v_max_f32_dpp v10, v10, v10 row_ror:8 row_mask:0xf bank_mask:0xf
  v_xor_b32 v45, s68, v97
  v_xor_b32 v46, s68, v98
  v_xor_b32 v47, s68, v99
  v_sub_f32 v10, v32, v10
  v_xor_b32 v48, s68, v100
  v_xor_b32 v49, s68, v101
  v_xor_b32 v50, s68, v102
  v_mul_f32 v10, s17, v10
  v_xor_b32 v51, s68, v103
  v_or3_b32 v15, v32, v33, v34
  v_or3_b32 v15, v15, v35, v36
  v_exp_f32 v10, v10
  v_or3_b32 v15, v15, v37, v38
  v_or3_b32 v15, v15, v39, v40
  v_or3_b32 v15, v15, v41, v42
  v_mul_f32 v11, v10, v33
  v_or3_b32 v15, v15, v43, v44
  v_or3_b32 v15, v15, v45, v46
  v_or3_b32 v15, v15, v47, v48
  v_or3_b32 v15, v15, v49, v50
  v_or_b32 v15, v15, v51
  v_and_b32 v15, 0xfff, v15
  v_cmp_ne_u32 vcc, 0, v15
  s_cbranch_vccz L_op_ok
  buffer_load_dwordx4 v[84:87], v9, s[60:63], s7 offen sc1
  buffer_load_dwordx4 v[88:91], v8, s[60:63], s6 offen offset:0 sc1
  buffer_load_dwordx4 v[92:95], v8, s[60:63], s6 offen offset:512 sc1
  buffer_load_dwordx4 v[96:99], v8, s[60:63], s6 offen offset:1024 sc1
  buffer_load_dwordx4 v[100:103], v8, s[60:63], s6 offen offset:1536 sc1
  s_cmp_eq_u32 s70, 0
  s_cbranch_scc1 L_op_ok
  s_sub_u32 s70, s70, 1
  s_branch L_op
L_op_ok:
  v_mul_f32_dpp v16, v10, v36 row_newbcast:0 row_mask:0xf bank_mask:0xf
  v_mul_f32_dpp v17, v10, v37 row_newbcast:0 row_mask:0xf bank_mask:0xf
  v_mul_f32_dpp v18, v10, v38 row_newbcast:0 row_mask:0xf bank_mask:0xf
  v_mul_f32_dpp v19, v10, v39 row_newbcast:0 row_mask:0xf bank_mask:0xf
  v_add_f32_dpp v11, v11, v11 row_ror:1 row_mask:0xf bank_mask:0xf
  v_fmac_f32_dpp v16, v10, v40 row_newbcast:1 row_mask:0xf bank_mask:0xf
  v_fmac_f32_dpp v17, v10, v41 row_newbcast:1 row_mask:0xf bank_mask:0xf
  v_fmac_f32_dpp v18, v10, v42 row_newbcast:1 row_mask:0xf bank_mask:0xf
  v_fmac_f32_dpp v19, v10, v43 row_newbcast:1 row_mask:0xf bank_mask:0xf
  v_add_f32_dpp v11, v11, v11 row_ror:2 row_mask:0xf bank_mask:0xf
  v_fmac_f32_dpp v16, v10, v44 row_newbcast:2 row_mask:0xf bank_mask:0xf
  v_fmac_f32_dpp v17, v10, v45 row_newbcast:2 row_mask:0xf bank_mask:0xf
  v_fmac_f32_dpp v18, v10, v46 row_newbcast:2 row_mask:0xf bank_mask:0xf
  v_fmac_f32_dpp v19, v10, v47 row_newbcast:2 row_mask:0xf bank_mask:0xf
  v_add_f32_dpp v11, v11, v11 row_ror:4 row_mask:0xf bank_mask:0xf
  v_fmac_f32_dpp v16, v10, v48 row_newbcast:3 row_mask:0xf bank_mask:0xf
  v_fmac_f32_dpp v17, v10, v49 row_newbcast:3 row_mask:0xf bank_mask:0xf
  v_fmac_f32_dpp v18, v10, v50 row_newbcast:3 row_mask:0xf bank_mask:0xf
  v_fmac_f32_dpp v19, v10, v51 row_newbcast:3 row_mask:0xf bank_mask:0xf
  v_add_f32_dpp v11, v11, v11 row_ror:8 row_mask:0xf bank_mask:0xf
  v_rcp_f32 v11, v11
  v_permlane32_swap_b32 v16, v18
  v_permlane32_swap_b32 v17, v19
  v_add_f32 v16, v16, v18
  v_add_f32 v17, v17, v19
  s_nop 1
  v_permlane16_swap_b32 v16, v17
  v_add_f32 v16, v16, v17
  v_mul_f32 v16, v16, v11
  v_cvt_pk_bf16_f32 v16, v16, v16
  ds_write_b32 v7, v16
  s_waitcnt lgkmcnt(0)
  s_barrier
L_fin:
  s_endpgm
L_red:
  s_mov_b64 exec, -1
  s_load_dwordx2 s[64:65], s[0:1], 72
  s_mov_b32 s30, 0x800
  s_mov_b32 s31, 0x20000
  s_mov_b32 s66, 0x800
  s_mov_b32 s67, 0x20000
  s_and_b32 s4, s2, 7
  s_lshl_b32 s4, s4, 3
  s_lshr_b32 s5, s2, 5
  s_add_u32 s4, s4, s5
  s_lshl_b32 s5, s4, 5
  s_lshl_b32 s6, s4, 6
  s_add_u32 s6, s6, 524288
  s_add_u32 s7, s6, 65536
  s_add_u32 s8, s6, 131072
  s_add_u32 s9, s6, 196608
  v_lshrrev_b32 v5, 2, v1
  v_and_b32 v6, 3, v1
  v_lshlrev_b32 v5, 12, v5
  v_lshl_add_u32 v5, v6, 4, v5
  v_bfe_u32 v7, v1, 4, 1
  v_lshlrev_b32 v6, 3, v6
  v_lshl_add_u32 v6, v7, 1, v6
  buffer_load_ushort v8, v6, s[28:31], s5 offen
  buffer_load_ushort v9, v6, s[28:31], s5 offen offset:4
  v_mov_b32 v12, s69
  v_mov_b32 v13, 0
  s_waitcnt lgkmcnt(0)
  buffer_load_dwordx4 v[96:99], v5, s[60:63], s6 offen sc1
  buffer_load_dwordx4 v[100:103], v5, s[60:63], s7 offen sc1
  buffer_load_dwordx4 v[104:107], v5, s[60:63], s8 offen sc1
  buffer_load_dwordx4 v[108:111], v5, s[60:63], s9 offen sc1
  s_sleep 1
  buffer_load_dwordx4 v[112:115], v5, s[60:63], s6 offen sc1
  buffer_load_dwordx4 v[116:119], v5, s[60:63], s7 offen sc1
  buffer_load_dwordx4 v[120:123], v5, s[60:63], s8 offen sc1
  buffer_load_dwordx4 v[124:127], v5, s[60:63], s9 offen sc1
L_rd:
  s_waitcnt vmcnt(4)
  v_xor_b32 v32, s68, v96
  v_xor_b32 v33, s68, v97
  v_xor_b32 v34, s68, v98
  v_xor_b32 v35, s68, v99
  v_xor_b32 v36, s68, v100
  v_xor_b32 v37, s68, v101
  v_xor_b32 v38, s68, v102
  v_xor_b32 v39, s68, v103
  v_xor_b32 v40, s68, v104
  v_xor_b32 v41, s68, v105
  v_xor_b32 v42, s68, v106
  v_xor_b32 v43, s68, v107
  v_xor_b32 v44, s68, v108
  v_xor_b32 v45, s68, v109
  v_xor_b32 v46, s68, v110
  v_xor_b32 v47, s68, v111
  v_or3_b32 v15, v32, v33, v34
  v_or3_b32 v15, v15, v35, v36
  v_or3_b32 v15, v15, v37, v38
  v_or3_b32 v15, v15, v39, v40
  v_or3_b32 v15, v15, v41, v42
  v_or3_b32 v15, v15, v43, v44
  v_or3_b32 v15, v15, v45, v46
  v_or_b32 v15, v15, v47
  v_and_b32 v15, 0xfff, v15
  v_cmp_ne_u32 vcc, 0, v15
  s_cbranch_vccz L_rd_ok
  buffer_load_dwordx4 v[96:99], v5, s[60:63], s6 offen sc1
  buffer_load_dwordx4 v[100:103], v5, s[60:63], s7 offen sc1
  buffer_load_dwordx4 v[104:107], v5, s[60:63], s8 offen sc1
  buffer_load_dwordx4 v[108:111], v5, s[60:63], s9 offen sc1
  s_waitcnt vmcnt(4)
  v_xor_b32 v32, s68, v112
  v_xor_b32 v33, s68, v113
  v_xor_b32 v34, s68, v114
  v_xor_b32 v35, s68, v115
  v_xor_b32 v36, s68, v116
  v_xor_b32 v37, s68, v117
  v_xor_b32 v38, s68, v118
  v_xor_b32 v39, s68, v119
  v_xor_b32 v40, s68, v120
  v_xor_b32 v41, s68, v121
  v_xor_b32 v42, s68, v122
  v_xor_b32 v43, s68, v123
  v_xor_b32 v44, s68, v124
  v_xor_b32 v45, s68, v125
  v_xor_b32 v46, s68, v126
  v_xor_b32 v47, s68, v127
  v_or3_b32 v15, v32, v33, v34
  v_or3_b32 v15, v15, v35, v36
  v_or3_b32 v15, v15, v37, v38
  v_or3_b32 v15, v15, v39, v40
  v_or3_b32 v15, v15, v41, v42
  v_or3_b32 v15, v15, v43, v44
  v_or3_b32 v15, v15, v45, v46
  v_or_b32 v15, v15, v47
  v_and_b32 v15, 0xfff, v15
  v_cmp_ne_u32 vcc, 0, v15
  s_cbranch_vccz L_rd_ok
  buffer_load_dwordx4 v[112:115], v5, s[60:63], s6 offen sc1
  buffer_load_dwordx4 v[116:119], v5, s[60:63], s7 offen sc1
  buffer_load_dwordx4 v[120:123], v5, s[60:63], s8 offen sc1
  buffer_load_dwordx4 v[124:127], v5, s[60:63], s9 offen sc1
  s_cmp_eq_u32 s70, 0
  s_cbranch_scc1 L_rd_ok
  s_sub_u32 s70, s70, 1
  s_branch L_rd
L_rd_ok:
  v_lshlrev_b32 v8, 16, v8
  v_lshlrev_b32 v9, 16, v9
  v_pk_add_f32 v[32:33], v[32:33], v[36:37]
  v_pk_add_f32 v[40:41], v[40:41], v[44:45]
  v_pk_add_f32 v[34:35], v[34:35], v[38:39]
  v_pk_add_f32 v[42:43], v[42:43], v[46:47]
  s_nop 0
  v_permlane32_swap_b32 v32, v40
  v_permlane32_swap_b32 v33, v41
  v_permlane32_swap_b32 v34, v42
  v_permlane32_swap_b32 v35, v43
  v_pk_add_f32 v[32:33], v[32:33], v[40:41]
  v_pk_add_f32 v[34:35], v[34:35], v[42:43]
  s_nop 0
  v_permlane16_swap_b32 v32, v33
  v_permlane16_swap_b32 v34, v35
  v_add_f32 v32, v32, v33
  v_add_f32 v34, v34, v35
  s_nop 0
  v_add_f32_dpp v32, v32, v32 row_ror:4 row_mask:0xf bank_mask:0xf
  v_add_f32_dpp v34, v34, v34 row_ror:4 row_mask:0xf bank_mask:0xf
  s_nop 0
  v_add_f32_dpp v32, v32, v32 row_ror:8 row_mask:0xf bank_mask:0xf
  v_add_f32_dpp v34, v34, v34 row_ror:8 row_mask:0xf bank_mask:0xf
  v_cvt_pk_bf16_f32 v32, 0, v32
  v_cvt_pk_bf16_f32 v34, 0, v34
  v_add_f32 v8, v8, v32
  v_add_f32 v9, v9, v34
  v_permlane32_swap_b32 v32, v33
  v_permlane32_swap_b32 v34, v35
  v_cvt_pk_bf16_f32 v8, 0, v8
  v_cvt_pk_bf16_f32 v9, 0, v9
  v_add_f32 v8, v8, v33
  v_add_f32 v9, v9, v35
  v_cvt_pk_bf16_f32 v8, v8, v9
  s_mov_b64 exec, 0xf000f
  buffer_store_short v8, v6, s[64:67], s5 offen
  buffer_store_short_d16_hi v8, v6, s[64:67], s5 offen offset:4
  s_cmp_lg_u32 s4, 0
  s_cbranch_scc1 L_rdone
  s_mov_b64 exec, 0x1
  buffer_store_dword v12, v13, s[60:63], 0 offen
L_rdone:
  s_endpgm
L_hpath:
  s_bfe_u32 s4, s71, 0x40002
  s_lshl_b32 s4, s4, 1
  s_and_b32 s10, s3, 1
  s_add_u32 s4, s4, s10
  s_cmp_lt_u32 s71, 192
  s_cselect_b32 s11, 20, 8
  s_cselect_b32 s12, 0, 10240
  s_lshl_b32 s13, s11, 1
  s_bfm_b64 exec, s13, 0
  s_lshl_b32 s11, s11, 4
  s_mul_i32 s4, s4, s11
  s_add_u32 s4, s4, s12
  s_add_u32 s4, s4, 1310720
  s_mul_i32 s13, s11, s10
  s_add_u32 s5, s4, 14336
  s_add_u32 s6, s4, 28672
  s_add_u32 s7, s4, 43008
  s_add_u32 s8, s4, 57344
  s_add_u32 s9, s4, 71680
  v_lshlrev_b32 v5, 3, v1
  v_add_u32 v7, s13, v5
  v_bfe_u32 v10, v7, 2, 3
  v_mul_u32_u24 v10, 80, v10
  v_lshrrev_b32 v7, 5, v7
  v_lshl_add_u32 v7, v7, 2, v10
  s_and_b32 s24, s3, 2
  s_mul_i32 s24, s24, 320
  s_add_u32 s24, s24, 12288
  v_add_u32 v7, s24, v7
  v_mov_b32 v8, 0xc0135761
  v_mov_b32 v9, 0xc0135761
  s_cmp_ge_u32 s71, 192
  s_cbranch_scc1 L_hnb
  s_barrier
L_hnb:
  buffer_load_dwordx2 v[48:49], v5, s[60:63], s4 offen sc1
  buffer_load_dwordx2 v[50:51], v5, s[60:63], s5 offen sc1
  buffer_load_dwordx2 v[52:53], v5, s[60:63], s6 offen sc1
  buffer_load_dwordx2 v[54:55], v5, s[60:63], s7 offen sc1
  buffer_load_dwordx2 v[56:57], v5, s[60:63], s8 offen sc1
  buffer_load_dwordx2 v[58:59], v5, s[60:63], s9 offen sc1
  s_sleep 1
  buffer_load_dwordx2 v[60:61], v5, s[60:63], s4 offen sc1
  buffer_load_dwordx2 v[62:63], v5, s[60:63], s5 offen sc1
  buffer_load_dwordx2 v[64:65], v5, s[60:63], s6 offen sc1
  buffer_load_dwordx2 v[66:67], v5, s[60:63], s7 offen sc1
  buffer_load_dwordx2 v[68:69], v5, s[60:63], s8 offen sc1
  buffer_load_dwordx2 v[70:71], v5, s[60:63], s9 offen sc1
L_hp:
  s_waitcnt vmcnt(6)
  v_xor_b32 v32, s68, v48
  v_xor_b32 v33, s68, v49
  v_xor_b32 v34, s68, v50
  v_xor_b32 v35, s68, v51
  v_xor_b32 v36, s68, v52
  v_xor_b32 v37, s68, v53
  v_xor_b32 v38, s68, v54
  v_xor_b32 v39, s68, v55
  v_xor_b32 v40, s68, v56
  v_xor_b32 v41, s68, v57
  v_xor_b32 v42, s68, v58
  v_xor_b32 v43, s68, v59
  v_or3_b32 v15, v32, v33, v34
  v_or3_b32 v15, v15, v35, v36
  v_or3_b32 v15, v15, v37, v38
  v_or3_b32 v15, v15, v39, v40
  v_or3_b32 v15, v15, v41, v42
  v_or_b32 v15, v15, v43
  v_and_b32 v15, 0xfff, v15
  v_cmp_ne_u32 vcc, 0, v15
  s_cbranch_vccz L_hp_ok
  buffer_load_dwordx2 v[48:49], v5, s[60:63], s4 offen sc1
  buffer_load_dwordx2 v[50:51], v5, s[60:63], s5 offen sc1
  buffer_load_dwordx2 v[52:53], v5, s[60:63], s6 offen sc1
  buffer_load_dwordx2 v[54:55], v5, s[60:63], s7 offen sc1
  buffer_load_dwordx2 v[56:57], v5, s[60:63], s8 offen sc1
  buffer_load_dwordx2 v[58:59], v5, s[60:63], s9 offen sc1
  s_waitcnt vmcnt(6)
  v_xor_b32 v32, s68, v60
  v_xor_b32 v33, s68, v61
  v_xor_b32 v34, s68, v62
  v_xor_b32 v35, s68, v63
  v_xor_b32 v36, s68, v64
  v_xor_b32 v37, s68, v65
  v_xor_b32 v38, s68, v66
  v_xor_b32 v39, s68, v67
  v_xor_b32 v40, s68, v68
  v_xor_b32 v41, s68, v69
  v_xor_b32 v42, s68, v70
  v_xor_b32 v43, s68, v71
  v_or3_b32 v15, v32, v33, v34
  v_or3_b32 v15, v15, v35, v36
  v_or3_b32 v15, v15, v37, v38
  v_or3_b32 v15, v15, v39, v40
  v_or3_b32 v15, v15, v41, v42
  v_or_b32 v15, v15, v43
  v_and_b32 v15, 0xfff, v15
  v_cmp_ne_u32 vcc, 0, v15
  s_cbranch_vccz L_hp_ok
  buffer_load_dwordx2 v[60:61], v5, s[60:63], s4 offen sc1
  buffer_load_dwordx2 v[62:63], v5, s[60:63], s5 offen sc1
  buffer_load_dwordx2 v[64:65], v5, s[60:63], s6 offen sc1
  buffer_load_dwordx2 v[66:67], v5, s[60:63], s7 offen sc1
  buffer_load_dwordx2 v[68:69], v5, s[60:63], s8 offen sc1
  buffer_load_dwordx2 v[70:71], v5, s[60:63], s9 offen sc1
  s_cmp_eq_u32 s70, 0
  s_cbranch_scc1 L_hp_ok
  s_sub_u32 s70, s70, 1
  s_branch L_hp
L_hp_ok:
  v_pk_add_f32 v[32:33], v[32:33], v[36:37]
  v_pk_add_f32 v[34:35], v[34:35], v[38:39]
  v_pk_add_f32 v[32:33], v[32:33], v[40:41]
  v_pk_add_f32 v[34:35], v[34:35], v[42:43]
  v_cvt_pk_bf16_f32 v32, 0, v32
  v_cvt_pk_bf16_f32 v33, 0, v33
  v_cvt_pk_bf16_f32 v34, 0, v34
  v_cvt_pk_bf16_f32 v35, 0, v35
  v_mul_f32 v36, v32, v32
  v_mul_f32 v37, v33, v33
  v_fmac_f32 v8, 0xbdd2d3e8, v36
  v_fmac_f32 v9, 0xbdd2d3e8, v37
  v_mul_f32 v36, v8, v32
  v_mul_f32 v37, v9, v33
  v_exp_f32 v36, v36
  v_exp_f32 v37, v37
  s_nop 0
  v_add_f32 v36, 1.0, v36
  v_add_f32 v37, 1.0, v37
  v_rcp_f32 v36, v36
  v_rcp_f32 v37, v37
  s_nop 0
  v_mul_f32 v36, v36, v32
  v_mul_f32 v37, v37, v33
  v_cvt_pk_bf16_f32 v36, 0, v36
  v_cvt_pk_bf16_f32 v37, 0, v37
  v_mul_f32 v36, v36, v34
  v_mul_f32 v37, v37, v35
  v_cvt_pk_bf16_f32 v36, v36, v36
  v_cvt_pk_bf16_f32 v37, v37, v37
  ds_write2_b32 v7, v36, v37 offset0:0 offset1:20
  s_waitcnt lgkmcnt(0)
  s_barrier
  s_cmp_lt_u32 s71, 192
  s_cbranch_scc1 L_fin
  s_cmp_eq_u32 s3, 6
  s_cbranch_scc1 L_red
  s_endpgm
L_tail:
  s_cmp_ge_u32 s71, 128
  s_cbranch_scc1 L_tailD
  buffer_load_dwordx4 v[120:123], v14, s[44:47], s72 offen nt
  s_add_u32 s72, s72, 16384
  buffer_load_dwordx4 v[124:127], v14, s[44:47], s72 offen nt
  s_add_u32 s72, s72, 16384
  s_waitcnt vmcnt(7)
  buffer_load_dwordx4 v[128:131], v14, s[44:47], s72 offen nt
  s_add_u32 s72, s72, 16384
  s_waitcnt vmcnt(7)
  buffer_load_dwordx4 v[132:135], v14, s[44:47], s72 offen nt
  s_add_u32 s72, s72, 16384
  s_waitcnt vmcnt(7)
  buffer_load_dwordx4 v[136:139], v14, s[44:47], s72 offen nt
  s_add_u32 s72, s72, 16384
  s_waitcnt vmcnt(7)
  buffer_load_dwordx4 v[140:143], v14, s[44:47], s72 offen nt
  s_add_u32 s72, s72, 16384
  s_waitcnt vmcnt(7)
  buffer_load_dwordx4 v[144:147], v14, s[44:47], s72 offen nt
  s_add_u32 s72, s72, 16384
  s_waitcnt vmcnt(7)
  buffer_load_dwordx4 v[148:151], v14, s[44:47], s72 offen nt
  s_add_u32 s72, s72, 16384
  s_waitcnt vmcnt(7)
  buffer_load_dwordx4 v[152:155], v14, s[44:47], s72 offen nt
  s_add_u32 s72, s72, 16384
  s_waitcnt vmcnt(7)
  buffer_load_dwordx4 v[156:159], v14, s[44:47], s72 offen nt
  s_add_u32 s72, s72, 16384
  v_mul_u32_u24 v5, 80, v2
  s_and_b32 s4, s3, 2
  s_mul_i32 s4, s4, 320
  s_add_u32 s4, s4, 12288
  v_add_u32 v5, s4, v5
  v_lshlrev_b32 v6, 1, v3
  v_and_b32 v13, 16, v1
  v_add_u32 v6, v6, v13
  s_lshl_b32 s4, s71, 10
  s_and_b32 s5, s2, 7
  s_lshl_b32 s5, s5, 9
  s_add_u32 s4, s4, s5
  s_and_b32 s5, s3, 1
  s_lshl_b32 s5, s5, 8
  s_add_u32 s4, s4, s5
  s_add_u32 s4, s4, 524288
  s_waitcnt vmcnt(2)
  s_barrier
  v_mov_b32 v13, 13856
  ds_read_b32 v13, v13
  s_waitcnt lgkmcnt(0)
  v_readfirstlane_b32 s5, v13
  s_barrier
  ds_read_b128 v[200:203], v5 offset:0
  ds_read_b128 v[204:207], v5 offset:16
  ds_read_b128 v[208:211], v5 offset:32
  ds_read_b128 v[212:215], v5 offset:48
  s_waitcnt lgkmcnt(3)
  v_and_b32 v32, v200, v8
  v_and_b32 v33, v200, v9
  v_and_b32 v34, v200, v10
  v_and_b32 v35, v200, v11
  v_and_b32 v36, v201, v8
  v_and_b32 v37, v201, v9
  v_and_b32 v38, v201, v10
  v_and_b32 v39, v201, v11
  s_waitcnt vmcnt(15)
  v_mfma_f32_16x16x32_bf16 v[16:19], v[32:35], v[96:99], 0
  v_and_b32 v40, v202, v8
  v_and_b32 v41, v202, v9
  v_and_b32 v42, v202, v10
  v_and_b32 v43, v202, v11
  s_waitcnt vmcnt(14)
  v_mfma_f32_16x16x32_bf16 v[16:19], v[36:39], v[100:103], v[16:19]
  v_and_b32 v44, v203, v8
  v_and_b32 v45, v203, v9
  v_and_b32 v46, v203, v10
  v_and_b32 v47, v203, v11
  s_waitcnt vmcnt(13)
  v_mfma_f32_16x16x32_bf16 v[16:19], v[40:43], v[104:107], v[16:19]
  s_waitcnt lgkmcnt(2)
  v_and_b32 v48, v204, v8
  v_and_b32 v49, v204, v9
  v_and_b32 v50, v204, v10
  v_and_b32 v51, v204, v11
  s_waitcnt vmcnt(12)
  v_mfma_f32_16x16x32_bf16 v[16:19], v[44:47], v[108:111], v[16:19]
  v_and_b32 v52, v205, v8
  v_and_b32 v53, v205, v9
  v_and_b32 v54, v205, v10
  v_and_b32 v55, v205, v11
  s_waitcnt vmcnt(11)
  v_mfma_f32_16x16x32_bf16 v[16:19], v[48:51], v[112:115], v[16:19]
  v_and_b32 v56, v206, v8
  v_and_b32 v57, v206, v9
  v_and_b32 v58, v206, v10
  v_and_b32 v59, v206, v11
  s_waitcnt vmcnt(10)
  v_mfma_f32_16x16x32_bf16 v[16:19], v[52:55], v[116:119], v[16:19]
  v_and_b32 v60, v207, v8
  v_and_b32 v61, v207, v9
  v_and_b32 v62, v207, v10
  v_and_b32 v63, v207, v11
  s_waitcnt vmcnt(9)
  v_mfma_f32_16x16x32_bf16 v[16:19], v[56:59], v[120:123], v[16:19]
  s_waitcnt lgkmcnt(1)
  v_and_b32 v64, v208, v8
  v_and_b32 v65, v208, v9
  v_and_b32 v66, v208, v10
  v_and_b32 v67, v208, v11
  s_waitcnt vmcnt(8)
  v_mfma_f32_16x16x32_bf16 v[16:19], v[60:63], v[124:127], v[16:19]
  v_and_b32 v68, v209, v8
  v_and_b32 v69, v209, v9
  v_and_b32 v70, v209, v10
  v_and_b32 v71, v209, v11
  s_waitcnt vmcnt(7)
  v_mfma_f32_16x16x32_bf16 v[16:19], v[64:67], v[128:131], v[16:19]
  v_and_b32 v72, v210, v8
  v_and_b32 v73, v210, v9
  v_and_b32 v74, v210, v10
  v_and_b32 v75, v210, v11
  s_waitcnt vmcnt(6)
  v_mfma_f32_16x16x32_bf16 v[16:19], v[68:71], v[132:135], v[16:19]
  v_and_b32 v76, v211, v8
  v_and_b32 v77, v211, v9
  v_and_b32 v78, v211, v10
  v_and_b32 v79, v211, v11
  s_waitcnt vmcnt(5)
  v_mfma_f32_16x16x32_bf16 v[16:19], v[72:75], v[136:139], v[16:19]
  s_waitcnt lgkmcnt(0)
  v_and_b32 v80, v212, v8
  v_and_b32 v81, v212, v9
  v_and_b32 v82, v212, v10
  v_and_b32 v83, v212, v11
  s_waitcnt vmcnt(4)
  v_mfma_f32_16x16x32_bf16 v[16:19], v[76:79], v[140:143], v[16:19]
  v_and_b32 v84, v213, v8
  v_and_b32 v85, v213, v9
  v_and_b32 v86, v213, v10
  v_and_b32 v87, v213, v11
  s_waitcnt vmcnt(3)
  v_mfma_f32_16x16x32_bf16 v[16:19], v[80:83], v[144:147], v[16:19]
  v_and_b32 v88, v214, v8
  v_and_b32 v89, v214, v9
  v_and_b32 v90, v214, v10
  v_and_b32 v91, v214, v11
  s_waitcnt vmcnt(2)
  v_mfma_f32_16x16x32_bf16 v[16:19], v[84:87], v[148:151], v[16:19]
  v_and_b32 v92, v215, v8
  v_and_b32 v93, v215, v9
  v_and_b32 v94, v215, v10
  v_and_b32 v95, v215, v11
  s_waitcnt vmcnt(1)
  v_mfma_f32_16x16x32_bf16 v[16:19], v[88:91], v[152:155], v[16:19]
  s_waitcnt vmcnt(0)
  v_mfma_f32_16x16x32_bf16 v[16:19], v[92:95], v[156:159], v[16:19]
  s_nop 7
  v_permlane32_swap_b32 v16, v32
  v_permlane32_swap_b32 v17, v33
  v_permlane32_swap_b32 v18, v34
  v_permlane32_swap_b32 v19, v35
  s_nop 0
  v_add_f32_dpp v16, v32, v16 row_shl:8 row_mask:0xf bank_mask:0xf bound_ctrl:0
  v_add_f32_dpp v17, v33, v17 row_shl:8 row_mask:0xf bank_mask:0xf bound_ctrl:0
  v_add_f32_dpp v18, v34, v18 row_shl:8 row_mask:0xf bank_mask:0xf bound_ctrl:0
  v_add_f32_dpp v19, v35, v19 row_shl:8 row_mask:0xf bank_mask:0xf bound_ctrl:0
  v_add_u32 v16, 0x800, v16
  v_add_u32 v17, 0x800, v17
  v_add_u32 v18, 0x800, v18
  v_add_u32 v19, 0x800, v19
  v_and_or_b32 v16, v16, v4, s68
  v_and_or_b32 v17, v17, v4, s68
  v_and_or_b32 v18, v18, v4, s68
  v_and_or_b32 v19, v19, v4, s68
  s_mov_b64 exec, 0xff00ff
  s_cmp_eq_u32 s5, 1
  s_cbranch_scc0 L_st6
  buffer_store_dwordx4 v[16:19], v6, s[60:63], s4 offen
  s_endpgm
L_st6:
  buffer_store_dwordx4 v[16:19], v6, s[60:63], s4 offen sc1
  s_endpgm
L_tailD:
  s_waitcnt vmcnt(5)
  buffer_load_dwordx4 v[120:123], v14, s[44:47], s72 offen nt
  s_add_u32 s72, s72, 16384
  s_waitcnt vmcnt(5)
  buffer_load_dwordx4 v[124:127], v14, s[44:47], s72 offen nt
  s_add_u32 s72, s72, 16384
  s_waitcnt vmcnt(5)
  buffer_load_dwordx4 v[128:131], v14, s[44:47], s72 offen nt
  s_add_u32 s72, s72, 16384
  s_waitcnt vmcnt(5)
  buffer_load_dwordx4 v[132:135], v14, s[44:47], s72 offen nt
  s_add_u32 s72, s72, 16384
  s_waitcnt vmcnt(5)
  buffer_load_dwordx4 v[136:139], v14, s[44:47], s72 offen nt
  s_add_u32 s72, s72, 16384
  s_waitcnt vmcnt(5)
  buffer_load_dwordx4 v[140:143], v14, s[44:47], s72 offen nt
  s_add_u32 s72, s72, 16384
  s_waitcnt vmcnt(5)
  buffer_load_dwordx4 v[144:147], v14, s[44:47], s72 offen nt
  s_add_u32 s72, s72, 16384
  s_waitcnt vmcnt(5)
  buffer_load_dwordx4 v[148:151], v14, s[44:47], s72 offen nt
  s_add_u32 s72, s72, 16384
  s_waitcnt vmcnt(5)
  buffer_load_dwordx4 v[152:155], v14, s[44:47], s72 offen nt
  s_add_u32 s72, s72, 16384
  s_waitcnt vmcnt(5)
  buffer_load_dwordx4 v[156:159], v14, s[44:47], s72 offen nt
  s_add_u32 s72, s72, 16384
  s_waitcnt vmcnt(5)
  s_barrier
  buffer_load_dwordx4 v[160:163], v14, s[44:47], s72 offen nt
  s_add_u32 s72, s72, 16384
  s_waitcnt vmcnt(5)
  buffer_load_dwordx4 v[164:167], v14, s[44:47], s72 offen nt
  s_add_u32 s72, s72, 16384
  s_waitcnt vmcnt(5)
  buffer_load_dwordx4 v[168:171], v14, s[44:47], s72 offen nt
  s_add_u32 s72, s72, 16384
  s_waitcnt vmcnt(5)
  buffer_load_dwordx4 v[172:175], v14, s[44:47], s72 offen nt
  s_add_u32 s72, s72, 16384
  v_mul_u32_u24 v5, 80, v2
  s_and_b32 s4, s3, 2
  s_mul_i32 s4, s4, 320
  s_add_u32 s4, s4, 12288
  v_add_u32 v5, s4, v5
  v_lshlrev_b32 v6, 1, v3
  v_and_b32 v13, 16, v1
  v_add_u32 v6, v6, v13
  s_lshl_b32 s4, s71, 10
  s_and_b32 s5, s2, 7
  s_lshl_b32 s5, s5, 9
  s_add_u32 s4, s4, s5
  s_and_b32 s5, s3, 1
  s_lshl_b32 s5, s5, 8
  s_add_u32 s4, s4, s5
  s_add_u32 s4, s4, 524288
  v_mov_b32 v13, 13856
  ds_read_b32 v13, v13
  s_waitcnt lgkmcnt(0)
  v_readfirstlane_b32 s5, v13
  s_barrier
  ds_read_b128 v[200:203], v5 offset:0
  ds_read_b128 v[204:207], v5 offset:16
  ds_read_b128 v[208:211], v5 offset:32
  ds_read_b128 v[212:215], v5 offset:48
  ds_read_b128 v[216:219], v5 offset:64
  s_waitcnt lgkmcnt(4)
  v_and_b32 v32, v200, v8
  v_and_b32 v33, v200, v9
  v_and_b32 v34, v200, v10
  v_and_b32 v35, v200, v11
  v_and_b32 v36, v201, v8
  v_and_b32 v37, v201, v9
  v_and_b32 v38, v201, v10
  v_and_b32 v39, v201, v11
  s_waitcnt vmcnt(19)
  v_mfma_f32_16x16x32_bf16 v[16:19], v[32:35], v[96:99], 0
  v_and_b32 v40, v202, v8
  v_and_b32 v41, v202, v9
  v_and_b32 v42, v202, v10
  v_and_b32 v43, v202, v11
  s_waitcnt vmcnt(18)
  v_mfma_f32_16x16x32_bf16 v[16:19], v[36:39], v[100:103], v[16:19]
  v_and_b32 v44, v203, v8
  v_and_b32 v45, v203, v9
  v_and_b32 v46, v203, v10
  v_and_b32 v47, v203, v11
  s_waitcnt vmcnt(17)
  v_mfma_f32_16x16x32_bf16 v[16:19], v[40:43], v[104:107], v[16:19]
  s_waitcnt lgkmcnt(3)
  v_and_b32 v48, v204, v8
  v_and_b32 v49, v204, v9
  v_and_b32 v50, v204, v10
  v_and_b32 v51, v204, v11
  s_waitcnt vmcnt(16)
  v_mfma_f32_16x16x32_bf16 v[16:19], v[44:47], v[108:111], v[16:19]
  v_and_b32 v52, v205, v8
  v_and_b32 v53, v205, v9
  v_and_b32 v54, v205, v10
  v_and_b32 v55, v205, v11
  s_waitcnt vmcnt(15)
  v_mfma_f32_16x16x32_bf16 v[16:19], v[48:51], v[112:115], v[16:19]
  v_and_b32 v56, v206, v8
  v_and_b32 v57, v206, v9
  v_and_b32 v58, v206, v10
  v_and_b32 v59, v206, v11
  s_waitcnt vmcnt(14)
  v_mfma_f32_16x16x32_bf16 v[16:19], v[52:55], v[116:119], v[16:19]
  v_and_b32 v60, v207, v8
  v_and_b32 v61, v207, v9
  v_and_b32 v62, v207, v10
  v_and_b32 v63, v207, v11
  s_waitcnt vmcnt(13)
  v_mfma_f32_16x16x32_bf16 v[16:19], v[56:59], v[120:123], v[16:19]
  s_waitcnt lgkmcnt(2)
  v_and_b32 v64, v208, v8
  v_and_b32 v65, v208, v9
  v_and_b32 v66, v208, v10
  v_and_b32 v67, v208, v11
  s_waitcnt vmcnt(12)
  v_mfma_f32_16x16x32_bf16 v[16:19], v[60:63], v[124:127], v[16:19]
  v_and_b32 v68, v209, v8
  v_and_b32 v69, v209, v9
  v_and_b32 v70, v209, v10
  v_and_b32 v71, v209, v11
  s_waitcnt vmcnt(11)
  v_mfma_f32_16x16x32_bf16 v[16:19], v[64:67], v[128:131], v[16:19]
  v_and_b32 v72, v210, v8
  v_and_b32 v73, v210, v9
  v_and_b32 v74, v210, v10
  v_and_b32 v75, v210, v11
  s_waitcnt vmcnt(10)
  v_mfma_f32_16x16x32_bf16 v[16:19], v[68:71], v[132:135], v[16:19]
  v_and_b32 v76, v211, v8
  v_and_b32 v77, v211, v9
  v_and_b32 v78, v211, v10
  v_and_b32 v79, v211, v11
  s_waitcnt vmcnt(9)
  v_mfma_f32_16x16x32_bf16 v[16:19], v[72:75], v[136:139], v[16:19]
  s_waitcnt lgkmcnt(1)
  v_and_b32 v80, v212, v8
  v_and_b32 v81, v212, v9
  v_and_b32 v82, v212, v10
  v_and_b32 v83, v212, v11
  s_waitcnt vmcnt(8)
  v_mfma_f32_16x16x32_bf16 v[16:19], v[76:79], v[140:143], v[16:19]
  v_and_b32 v84, v213, v8
  v_and_b32 v85, v213, v9
  v_and_b32 v86, v213, v10
  v_and_b32 v87, v213, v11
  s_waitcnt vmcnt(7)
  v_mfma_f32_16x16x32_bf16 v[16:19], v[80:83], v[144:147], v[16:19]
  v_and_b32 v88, v214, v8
  v_and_b32 v89, v214, v9
  v_and_b32 v90, v214, v10
  v_and_b32 v91, v214, v11
  s_waitcnt vmcnt(6)
  v_mfma_f32_16x16x32_bf16 v[16:19], v[84:87], v[148:151], v[16:19]
  v_and_b32 v92, v215, v8
  v_and_b32 v93, v215, v9
  v_and_b32 v94, v215, v10
  v_and_b32 v95, v215, v11
  s_waitcnt vmcnt(5)
  v_mfma_f32_16x16x32_bf16 v[16:19], v[88:91], v[152:155], v[16:19]
  s_waitcnt lgkmcnt(0)
  v_and_b32 v32, v216, v8
  v_and_b32 v33, v216, v9
  v_and_b32 v34, v216, v10
  v_and_b32 v35, v216, v11
  s_waitcnt vmcnt(4)
  v_mfma_f32_16x16x32_bf16 v[16:19], v[92:95], v[156:159], v[16:19]
  v_and_b32 v36, v217, v8
  v_and_b32 v37, v217, v9
  v_and_b32 v38, v217, v10
  v_and_b32 v39, v217, v11
  s_waitcnt vmcnt(3)
  v_mfma_f32_16x16x32_bf16 v[16:19], v[32:35], v[160:163], v[16:19]
  v_and_b32 v40, v218, v8
  v_and_b32 v41, v218, v9
  v_and_b32 v42, v218, v10
  v_and_b32 v43, v218, v11
  s_waitcnt vmcnt(2)
  v_mfma_f32_16x16x32_bf16 v[16:19], v[36:39], v[164:167], v[16:19]
  v_and_b32 v44, v219, v8
  v_and_b32 v45, v219, v9
  v_and_b32 v46, v219, v10
  v_and_b32 v47, v219, v11
  s_waitcnt vmcnt(1)
  v_mfma_f32_16x16x32_bf16 v[16:19], v[40:43], v[168:171], v[16:19]
  s_waitcnt vmcnt(0)
  v_mfma_f32_16x16x32_bf16 v[16:19], v[44:47], v[172:175], v[16:19]
  s_nop 7
  v_permlane32_swap_b32 v16, v32
  v_permlane32_swap_b32 v17, v33
  v_permlane32_swap_b32 v18, v34
  v_permlane32_swap_b32 v19, v35
  s_nop 0
  v_add_f32_dpp v16, v32, v16 row_shl:8 row_mask:0xf bank_mask:0xf bound_ctrl:0
  v_add_f32_dpp v17, v33, v17 row_shl:8 row_mask:0xf bank_mask:0xf bound_ctrl:0
  v_add_f32_dpp v18, v34, v18 row_shl:8 row_mask:0xf bank_mask:0xf bound_ctrl:0
  v_add_f32_dpp v19, v35, v19 row_shl:8 row_mask:0xf bank_mask:0xf bound_ctrl:0
  v_add_u32 v16, 0x800, v16
  v_add_u32 v17, 0x800, v17
  v_add_u32 v18, 0x800, v18
  v_add_u32 v19, 0x800, v19
  v_and_or_b32 v16, v16, v4, s68
  v_and_or_b32 v17, v17, v4, s68
  v_and_or_b32 v18, v18, v4, s68
  v_and_or_b32 v19, v19, v4, s68
  s_mov_b64 exec, 0xff00ff
  s_cmp_eq_u32 s5, 1
  s_cbranch_scc0 L_st7
  buffer_store_dwordx4 v[16:19], v6, s[60:63], s4 offen
  s_endpgm
L_st7:
  buffer_store_dwordx4 v[16:19], v6, s[60:63], s4 offen sc1
  s_endpgm
L_end:
  s_endpgm
.p2align 2
.type L_tiles,@object
L_tiles:
.byte 16,8,144,144,16,152,16,16,152,64,64,64,24,16,152,24
.byte 24,144,8,152,152,24,24,152,32,16,152,160,32,160,32,32
.byte 160,72,72,72,40,32,160,40,40,152,16,168,160,40,40,160
.byte 48,24,160,176,48,168,48,48,168,80,80,80,56,48,168,56
.byte 56,160,24,184,168,56,56,168,64,32,168,0,64,176,64,64
.byte 176,88,88,88,72,64,176,72,72,168,32,8,176,72,72,176
.byte 80,40,176,16,80,184,80,80,184,96,96,96,88,80,184,88
.byte 88,176,40,24,184,88,88,184,96,48,184,32,96,0,96,96
.byte 0,104,104,104,104,96,0,104,104,184,48,40,0,104,104,0
.byte 112,56,0,48,112,8,112,112,8,112,112,112,120,112,8,120
.byte 120,0,56,56,8,120,120,8,136,136,128,128,136,136,144,136
.byte 128,120,120,120,144,144,136,144,144,128,136,136,128,128,128,128
.size L_tiles, 192
.section .rodata,"a"
.p2align 6
.amdhsa_kernel parallel_sum__sliding_block_cached__glu_gated_geglu__decode_kernel
  .amdhsa_next_free_vgpr 256
  .amdhsa_next_free_sgpr 102
  .amdhsa_accum_offset 256
  .amdhsa_group_segment_fixed_size 0
  .amdhsa_kernarg_size 96
  .amdhsa_user_sgpr_count 2
  .amdhsa_user_sgpr_kernarg_segment_ptr 1
  .amdhsa_system_sgpr_workgroup_id_x 1
.end_amdhsa_kernel
```
